```python
import torch

def _softmax(x, axis=-1):
    return torch.softmax(x, dim=axis)

def _gelu(x):
    return torch.nn.functional.gelu(x, approximate='tanh')

def _silu(x):
    return torch.nn.functional.silu(x)

def _sigmoid(x):
    return torch.sigmoid(x)

def _layernorm(x, axis=-1, eps=1e-05):
    m = x.mean(dim=axis, keepdim=True)
    v = x.var(dim=axis, keepdim=True, unbiased=False)
    return (x - m) / torch.sqrt(v + eps)

def _scatter_add(tgt, idx, src, axis=0):
    return tgt.clone().index_add_(axis, idx, src)

def _segment_sum(src, seg, n):
    out = torch.zeros((n,) + src.shape[1:], dtype=src.dtype)
    return out.index_add_(0, seg, src)

def _pad(x, pw):
    flat = tuple((v for pair in reversed(pw) for v in pair))
    return torch.nn.functional.pad(x, flat)
kernel_name = 'gather_scatter__molecular_angular_painn__graph'

def setup_inputs():

    _w = lambda a: (lambda t: t.to(torch.bfloat16) if t.is_floating_point() else t)(torch.as_tensor(a))
    N, deg, D = (12500, 64, 64)
    n_rbf = max(16, 4)
    E = N * deg
    cutoff = 5.0
    freqs = (torch.arange(1, n_rbf + 1) * torch.pi / cutoff).to(float)
    return {'sv': _w((lambda *s: torch.randn(*s, dtype=torch.bfloat16) * 0.4)(N, 4, D) * 0.3), 'pos': _w((lambda *s: torch.randn(*s, dtype=torch.bfloat16) * 0.8)(N, 3) * 1.2), 'src': _w((lambda lo, hi, *s: torch.randint(lo, hi, s))(0, N, E).to(torch.int64)), 'dst': _w((lambda lo, hi, *s: torch.randint(lo, hi, s))(0, N, E).to(torch.int64)), 'freqs': _w(freqs), 'w_phi1': _w((lambda *s: torch.randn(*s, dtype=torch.bfloat16) * 3.2)(D, D) / D ** 0.5), 'w_phi2': _w((lambda *s: torch.randn(*s, dtype=torch.bfloat16) * 0.8)(D, 3 * D) / D ** 0.5), 'w_rbf': _w((lambda *s: torch.randn(*s, dtype=torch.bfloat16) * 0.8)(n_rbf, 3 * D) / n_rbf ** 0.5)}

def reference(sv, pos, src, dst, freqs, w_phi1, w_phi2, w_rbf):
    N, _, D = sv.shape
    E = src.shape[0]
    PI, cutoff = (3.141592653589793, 5.0)
    s, v = (sv[:, 0, :].clone(), sv[:, 1:, :].clone())
    r_vec = pos[src] - pos[dst]
    d = torch.sqrt((r_vec * r_vec).sum(-1) + 1e-08)
    r_hat = r_vec / d[:, None]
    rbf = torch.sin(d[:, None] * freqs[None, :]) / d[:, None]
    fcut = 0.5 * (torch.cos(PI * d / cutoff) + 1.0)
    fcut = torch.where(d < cutoff, fcut, 0.0 * d)
    Wf = rbf @ w_rbf * fcut[:, None]
    phi = (_silu(s @ w_phi1) @ w_phi2)[src]
    m = phi * Wf
    m_s, m_vv, m_vr = (m[:, :D].clone(), m[:, D:2 * D].clone(), m[:, 2 * D:].clone())
    ds = _segment_sum(m_s, dst, N)
    dv_e = m_vv[:, None, :] * v[src] + m_vr[:, None, :] * r_hat[:, :, None]
    dv = _segment_sum(dv_e.reshape(E, 3 * D), dst, N).reshape(N, 3, D)
    return sv + torch.concatenate([ds[:, None, :], dv], axis=1)
```

```asm
; @launch kernel=k1_kernel grid=(448,1,1) block=(512,1,1) lds=16384
; @launch kernel=k2_kernel grid=(256,1,1) block=(512,1,1) lds=160640
.amdgcn_target "amdgcn-amd-amdhsa--gfx950"
.text
.globl k1_kernel
.p2align 8
.type k1_kernel,@function
k1_kernel:
    s_load_dwordx4 s[4:7], s[0:1], 0
    s_load_dwordx4 s[8:11], s[0:1], 16
    s_load_dwordx4 s[12:15], s[0:1], 32
    s_load_dwordx4 s[16:19], s[0:1], 48
    s_load_dwordx2 s[20:21], s[0:1], 80
    s_cmp_ge_u32 s2, 448
    s_cbranch_scc1 K1_END
    s_mov_b32 s22, 0xffff0000
    s_mov_b32 s47, 0x40a00000
    s_mov_b32 s99, s2
    s_waitcnt lgkmcnt(0)
    s_cmp_lt_u32 s2, 198
    s_cbranch_scc1 K1_NOTEDGE
    s_sub_u32 s2, s2, 198
    s_mov_b32 s24, s8
    s_and_b32 s25, s9, 0xffff
    s_mov_b32 s26, 3200000
    s_mov_b32 s27, 0x20000
    s_mov_b32 s28, s10
    s_and_b32 s29, s11, 0xffff
    s_mov_b32 s30, 3200000
    s_mov_b32 s31, 0x20000
    s_mov_b32 s36, s20
    s_and_b32 s37, s21, 0xffff
    s_mov_b32 s38, 33816576
    s_mov_b32 s39, 0x20000
    s_mul_i32 s3, s2, 12800
    v_lshlrev_b32 v1, 4, v0
    v_cmp_gt_u32 vcc, 400, v0
    s_nop 0
    s_and_saveexec_b64 s[40:41], vcc
    s_mov_b64 s[42:43], exec
    buffer_load_dwordx4 v[4:7], v1, s[28:31], s3 offen
    buffer_load_dwordx4 v[12:15], v1, s[24:27], s3 offen
    s_add_u32 s4, s3, 6400
    buffer_load_dwordx4 v[8:11], v1, s[28:31], s4 offen
    buffer_load_dwordx4 v[16:19], v1, s[24:27], s4 offen
    s_mov_b64 exec, s[40:41]
    v_mov_b32 v60, 0
    v_mov_b32 v61, 0
    v_mov_b32 v62, 0
    v_mov_b32 v63, 0
    v_cmp_gt_u32 vcc, 64, v0
    s_nop 0
    s_and_saveexec_b64 s[44:45], vcc
    v_add_u32 v2, 12800, v1
    ds_write_b128 v2, v[60:63]
    s_mov_b64 exec, s[40:41]
    s_mov_b32 s46, 87960931
    v_mov_b32 v40, 1
    s_waitcnt lgkmcnt(0)
    s_barrier
    s_mov_b64 exec, s[42:43]
    s_waitcnt vmcnt(3)
    v_mul_hi_u32 v20, v4, s46
    v_lshlrev_b32 v20, 2, v20
    v_add_u32 v20, 12800, v20
    ds_add_rtn_u32 v28, v20, v40
    v_mul_hi_u32 v21, v5, s46
    v_lshlrev_b32 v21, 2, v21
    v_add_u32 v21, 12800, v21
    ds_add_rtn_u32 v29, v21, v40
    v_mul_hi_u32 v22, v6, s46
    v_lshlrev_b32 v22, 2, v22
    v_add_u32 v22, 12800, v22
    ds_add_rtn_u32 v30, v22, v40
    v_mul_hi_u32 v23, v7, s46
    v_lshlrev_b32 v23, 2, v23
    v_add_u32 v23, 12800, v23
    ds_add_rtn_u32 v31, v23, v40
    s_waitcnt vmcnt(1)
    v_mul_hi_u32 v24, v8, s46
    v_lshlrev_b32 v24, 2, v24
    v_add_u32 v24, 12800, v24
    ds_add_rtn_u32 v32, v24, v40
    v_mul_hi_u32 v25, v9, s46
    v_lshlrev_b32 v25, 2, v25
    v_add_u32 v25, 12800, v25
    ds_add_rtn_u32 v33, v25, v40
    v_mul_hi_u32 v26, v10, s46
    v_lshlrev_b32 v26, 2, v26
    v_add_u32 v26, 12800, v26
    ds_add_rtn_u32 v34, v26, v40
    v_mul_hi_u32 v27, v11, s46
    v_lshlrev_b32 v27, 2, v27
    v_add_u32 v27, 12800, v27
    ds_add_rtn_u32 v35, v27, v40
    s_waitcnt vmcnt(0)
    v_lshl_or_b32 v44, v4, 16, v12
    v_lshl_or_b32 v45, v5, 16, v13
    v_lshl_or_b32 v46, v6, 16, v14
    v_lshl_or_b32 v47, v7, 16, v15
    v_lshl_or_b32 v48, v8, 16, v16
    v_lshl_or_b32 v49, v9, 16, v17
    v_lshl_or_b32 v50, v10, 16, v18
    v_lshl_or_b32 v51, v11, 16, v19
    s_mov_b64 exec, s[40:41]
    s_waitcnt lgkmcnt(0)
    s_barrier
    v_lshrrev_b32 v1, 6, v0
    s_nop 0
    v_readfirstlane_b32 s4, v1
    s_nop 0
    s_cmp_lg_u32 s4, 0
    s_cbranch_scc1 K1_E_SCANDONE
    v_lshlrev_b32 v1, 4, v0
    v_add_u32 v2, 12800, v1
    ds_read_b128 v[80:83], v2
    s_waitcnt lgkmcnt(0)
    v_add_u32 v84, v80, v81
    v_add_u32 v85, v84, v82
    v_add_u32 v86, v85, v83
    v_mov_b32 v87, v86
    s_nop 1
    v_add_u32_dpp v87, v87, v87 row_shr:1 row_mask:0xf bank_mask:0xf
    s_nop 1
    v_add_u32_dpp v87, v87, v87 row_shr:2 row_mask:0xf bank_mask:0xf
    s_nop 1
    v_add_u32_dpp v87, v87, v87 row_shr:4 row_mask:0xf bank_mask:0xf
    s_nop 1
    v_add_u32_dpp v87, v87, v87 row_shr:8 row_mask:0xf bank_mask:0xf
    s_nop 1
    v_add_u32_dpp v87, v87, v87 row_bcast:15 row_mask:0xa bank_mask:0xf
    s_nop 1
    v_add_u32_dpp v87, v87, v87 row_bcast:31 row_mask:0xc bank_mask:0xf
    v_sub_u32 v88, v87, v86
    v_add_u32 v89, v88, v80
    v_add_u32 v90, v88, v84
    v_add_u32 v91, v88, v85
    ds_write_b128 v2, v[88:91]
    v_lshlrev_b32 v1, 12, v0
    s_lshl_b32 s4, s2, 2
    s_add_u32 s4, s4, 6488064
    v_lshl_or_b32 v92, v80, 16, v88
    buffer_store_dword v92, v1, s[36:39], s4 offen offset:0
    v_lshl_or_b32 v93, v81, 16, v89
    buffer_store_dword v93, v1, s[36:39], s4 offen offset:1024
    v_lshl_or_b32 v94, v82, 16, v90
    buffer_store_dword v94, v1, s[36:39], s4 offen offset:2048
    v_lshl_or_b32 v95, v83, 16, v91
    buffer_store_dword v95, v1, s[36:39], s4 offen offset:3072
    s_waitcnt lgkmcnt(0)
K1_E_SCANDONE:
    s_barrier
    s_mov_b64 exec, s[42:43]
    ds_read_b32 v20, v20
    ds_read_b32 v21, v21
    ds_read_b32 v22, v22
    ds_read_b32 v23, v23
    ds_read_b32 v24, v24
    ds_read_b32 v25, v25
    ds_read_b32 v26, v26
    ds_read_b32 v27, v27
    s_waitcnt lgkmcnt(7)
    v_add_lshl_u32 v20, v20, v28, 2
    ds_write_b32 v20, v44
    s_waitcnt lgkmcnt(6)
    v_add_lshl_u32 v21, v21, v29, 2
    ds_write_b32 v21, v45
    s_waitcnt lgkmcnt(5)
    v_add_lshl_u32 v22, v22, v30, 2
    ds_write_b32 v22, v46
    s_waitcnt lgkmcnt(4)
    v_add_lshl_u32 v23, v23, v31, 2
    ds_write_b32 v23, v47
    s_waitcnt lgkmcnt(3)
    v_add_lshl_u32 v24, v24, v32, 2
    ds_write_b32 v24, v48
    s_waitcnt lgkmcnt(2)
    v_add_lshl_u32 v25, v25, v33, 2
    ds_write_b32 v25, v49
    s_waitcnt lgkmcnt(1)
    v_add_lshl_u32 v26, v26, v34, 2
    ds_write_b32 v26, v50
    s_waitcnt lgkmcnt(0)
    v_add_lshl_u32 v27, v27, v35, 2
    ds_write_b32 v27, v51
    s_mov_b64 exec, s[40:41]
    s_waitcnt lgkmcnt(0)
    s_barrier
    v_lshlrev_b32 v1, 4, v0
    s_mul_i32 s4, s2, 12800
    s_add_u32 s4, s4, 7340032
    ds_read_b128 v[80:83], v1
    v_cmp_gt_u32 vcc, 288, v0
    s_nop 0
    s_and_saveexec_b64 s[44:45], vcc
    ds_read_b128 v[84:87], v1 offset:8192
    s_mov_b64 exec, s[40:41]
    s_waitcnt lgkmcnt(0)
    buffer_store_dwordx4 v[80:83], v1, s[36:39], s4 offen
    s_add_u32 s4, s4, 8192
    v_cmp_gt_u32 vcc, 288, v0
    s_nop 0
    s_and_saveexec_b64 s[44:45], vcc
    buffer_store_dwordx4 v[84:87], v1, s[36:39], s4 offen
    s_endpgm
K1_NOTEDGE:
    s_cmp_ge_u32 s2, 196
    s_cbranch_scc1 K1_CONST
    s_mov_b32 s24, s4
    s_and_b32 s25, s5, 0xffff
    s_mov_b32 s26, 6400000
    s_mov_b32 s27, 0x20000
    s_mov_b32 s28, s14
    s_and_b32 s29, s15, 0xffff
    s_mov_b32 s30, 8192
    s_mov_b32 s31, 0x20000
    s_mov_b32 s32, s16
    s_and_b32 s33, s17, 0xffff
    s_mov_b32 s34, 24576
    s_mov_b32 s35, 0x20000
    s_mov_b32 s36, s20
    s_and_b32 s37, s21, 0xffff
    s_mov_b32 s38, 6400000
    s_mov_b32 s39, 0x20000
    v_lshlrev_b32 v1, 4, v0
    buffer_load_dwordx4 v[4:7], v1, s[28:31], 0 offen
    v_lshrrev_b32 v2, 3, v0
    v_mul_u32_u24 v2, 384, v2
    v_and_b32 v3, 7, v0
    v_lshl_add_u32 v2, v3, 4, v2
    buffer_load_dwordx4 v[8:11], v2, s[32:35], 0 offen offset:128
    s_barrier
    v_and_b32 v12, 63, v0
    v_lshrrev_b32 v13, 6, v0
    v_and_b32 v14, 15, v12
    v_lshrrev_b32 v15, 4, v12
    s_lshl_b32 s3, s2, 6
    v_lshl_add_u32 v16, v13, 4, v14
    v_add_u32 v16, s3, v16
    v_lshlrev_b32 v17, 9, v16
    v_lshl_add_u32 v18, v15, 4, v17
    v_readfirstlane_b32 s4, v13
    s_nop 0
    s_cmp_ge_u32 s4, 4
    s_cbranch_scc1 K1_N_HELP
    buffer_load_dwordx4 v[20:23], v18, s[24:27], 0 offen
    buffer_load_dwordx4 v[24:27], v18, s[24:27], 0 offen offset:64
    buffer_load_dwordx4 v[28:31], v18, s[24:27], 0 offen offset:128
    buffer_load_dwordx4 v[32:35], v18, s[24:27], 0 offen offset:192
    buffer_load_dwordx4 v[36:39], v18, s[24:27], 0 offen offset:256
    buffer_load_dwordx4 v[40:43], v18, s[24:27], 0 offen offset:320
    buffer_load_dwordx4 v[44:47], v18, s[24:27], 0 offen offset:384
    buffer_load_dwordx4 v[48:51], v18, s[24:27], 0 offen offset:448
    s_waitcnt vmcnt(8)
    s_branch K1_N_W
K1_N_HELP:
    s_waitcnt vmcnt(0)
    ds_write_b128 v1, v[4:7]
    ds_write_b128 v1, v[8:11] offset:8192
    s_waitcnt lgkmcnt(0)
    s_barrier
    s_endpgm
K1_N_W:
    ds_write_b128 v1, v[4:7]
    ds_write_b128 v1, v[8:11] offset:8192
    v_lshrrev_b32 v2, 2, v14
    v_and_b32 v3, 3, v14
    v_lshl_add_u32 v4, v15, 3, v2
    v_lshlrev_b32 v4, 7, v4
    v_lshl_add_u32 v4, v3, 4, v4
    s_waitcnt lgkmcnt(0)
    s_barrier
    ds_read_b64_tr_b16 v[52:53], v4 offset:0
    ds_read_b64_tr_b16 v[54:55], v4 offset:512
    ds_read_b64_tr_b16 v[56:57], v4 offset:4096
    ds_read_b64_tr_b16 v[58:59], v4 offset:4608
    ds_read_b64_tr_b16 v[60:61], v4 offset:8
    ds_read_b64_tr_b16 v[62:63], v4 offset:520
    ds_read_b64_tr_b16 v[64:65], v4 offset:4104
    ds_read_b64_tr_b16 v[66:67], v4 offset:4616
    ds_read_b64_tr_b16 v[68:69], v4 offset:64
    ds_read_b64_tr_b16 v[70:71], v4 offset:576
    ds_read_b64_tr_b16 v[72:73], v4 offset:4160
    ds_read_b64_tr_b16 v[74:75], v4 offset:4672
    ds_read_b64_tr_b16 v[76:77], v4 offset:72
    ds_read_b64_tr_b16 v[78:79], v4 offset:584
    ds_read_b64_tr_b16 v[80:81], v4 offset:4168
    ds_read_b64_tr_b16 v[82:83], v4 offset:4680
    s_waitcnt vmcnt(6) lgkmcnt(0)
    v_mfma_f32_16x16x32_bf16 v[84:87], v[52:55], v[20:23], 0
    v_mfma_f32_16x16x32_bf16 v[88:91], v[60:63], v[20:23], 0
    v_mfma_f32_16x16x32_bf16 v[92:95], v[68:71], v[20:23], 0
    v_mfma_f32_16x16x32_bf16 v[96:99], v[76:79], v[20:23], 0
    v_mfma_f32_16x16x32_bf16 v[84:87], v[56:59], v[24:27], v[84:87]
    v_mfma_f32_16x16x32_bf16 v[88:91], v[64:67], v[24:27], v[88:91]
    v_mfma_f32_16x16x32_bf16 v[92:95], v[72:75], v[24:27], v[92:95]
    v_mfma_f32_16x16x32_bf16 v[96:99], v[80:83], v[24:27], v[96:99]
    ds_read_b64_tr_b16 v[52:53], v4 offset:8192
    ds_read_b64_tr_b16 v[54:55], v4 offset:8704
    ds_read_b64_tr_b16 v[56:57], v4 offset:12288
    ds_read_b64_tr_b16 v[58:59], v4 offset:12800
    ds_read_b64_tr_b16 v[60:61], v4 offset:8200
    ds_read_b64_tr_b16 v[62:63], v4 offset:8712
    ds_read_b64_tr_b16 v[64:65], v4 offset:12296
    ds_read_b64_tr_b16 v[66:67], v4 offset:12808
    ds_read_b64_tr_b16 v[68:69], v4 offset:8256
    ds_read_b64_tr_b16 v[70:71], v4 offset:8768
    ds_read_b64_tr_b16 v[72:73], v4 offset:12352
    ds_read_b64_tr_b16 v[74:75], v4 offset:12864
    ds_read_b64_tr_b16 v[76:77], v4 offset:8264
    ds_read_b64_tr_b16 v[78:79], v4 offset:8776
    ds_read_b64_tr_b16 v[80:81], v4 offset:12360
    ds_read_b64_tr_b16 v[82:83], v4 offset:12872
    v_cvt_pk_bf16_f32 v6, v84, v85
    v_lshlrev_b32 v84, 16, v6
    v_and_b32 v85, s22, v6
    v_mul_f32 v7, 0xbfb8aa3b, v84
    v_mul_f32 v8, 0xbfb8aa3b, v85
    v_exp_f32 v7, v7
    v_exp_f32 v8, v8
    v_add_f32 v7, 1.0, v7
    v_add_f32 v8, 1.0, v8
    v_rcp_f32 v7, v7
    v_rcp_f32 v8, v8
    v_mul_f32 v7, v7, v84
    v_mul_f32 v8, v8, v85
    v_cvt_pk_bf16_f32 v100, v7, v8
    v_cvt_pk_bf16_f32 v6, v86, v87
    v_lshlrev_b32 v86, 16, v6
    v_and_b32 v87, s22, v6
    v_mul_f32 v9, 0xbfb8aa3b, v86
    v_mul_f32 v10, 0xbfb8aa3b, v87
    v_exp_f32 v9, v9
    v_exp_f32 v10, v10
    v_add_f32 v9, 1.0, v9
    v_add_f32 v10, 1.0, v10
    v_rcp_f32 v9, v9
    v_rcp_f32 v10, v10
    v_mul_f32 v9, v9, v86
    v_mul_f32 v10, v10, v87
    v_cvt_pk_bf16_f32 v101, v9, v10
    v_cvt_pk_bf16_f32 v6, v88, v89
    v_lshlrev_b32 v88, 16, v6
    v_and_b32 v89, s22, v6
    v_mul_f32 v7, 0xbfb8aa3b, v88
    v_mul_f32 v8, 0xbfb8aa3b, v89
    v_exp_f32 v7, v7
    v_exp_f32 v8, v8
    v_add_f32 v7, 1.0, v7
    v_add_f32 v8, 1.0, v8
    v_rcp_f32 v7, v7
    v_rcp_f32 v8, v8
    v_mul_f32 v7, v7, v88
    v_mul_f32 v8, v8, v89
    v_cvt_pk_bf16_f32 v102, v7, v8
    v_cvt_pk_bf16_f32 v6, v90, v91
    v_lshlrev_b32 v90, 16, v6
    v_and_b32 v91, s22, v6
    v_mul_f32 v9, 0xbfb8aa3b, v90
    v_mul_f32 v10, 0xbfb8aa3b, v91
    v_exp_f32 v9, v9
    v_exp_f32 v10, v10
    v_add_f32 v9, 1.0, v9
    v_add_f32 v10, 1.0, v10
    v_rcp_f32 v9, v9
    v_rcp_f32 v10, v10
    v_mul_f32 v9, v9, v90
    v_mul_f32 v10, v10, v91
    v_cvt_pk_bf16_f32 v103, v9, v10
    v_cvt_pk_bf16_f32 v6, v92, v93
    v_lshlrev_b32 v92, 16, v6
    v_and_b32 v93, s22, v6
    v_mul_f32 v7, 0xbfb8aa3b, v92
    v_mul_f32 v8, 0xbfb8aa3b, v93
    v_exp_f32 v7, v7
    v_exp_f32 v8, v8
    v_add_f32 v7, 1.0, v7
    v_add_f32 v8, 1.0, v8
    v_rcp_f32 v7, v7
    v_rcp_f32 v8, v8
    v_mul_f32 v7, v7, v92
    v_mul_f32 v8, v8, v93
    v_cvt_pk_bf16_f32 v104, v7, v8
    v_cvt_pk_bf16_f32 v6, v94, v95
    v_lshlrev_b32 v94, 16, v6
    v_and_b32 v95, s22, v6
    v_mul_f32 v9, 0xbfb8aa3b, v94
    v_mul_f32 v10, 0xbfb8aa3b, v95
    v_exp_f32 v9, v9
    v_exp_f32 v10, v10
    v_add_f32 v9, 1.0, v9
    v_add_f32 v10, 1.0, v10
    v_rcp_f32 v9, v9
    v_rcp_f32 v10, v10
    v_mul_f32 v9, v9, v94
    v_mul_f32 v10, v10, v95
    v_cvt_pk_bf16_f32 v105, v9, v10
    v_cvt_pk_bf16_f32 v6, v96, v97
    v_lshlrev_b32 v96, 16, v6
    v_and_b32 v97, s22, v6
    v_mul_f32 v7, 0xbfb8aa3b, v96
    v_mul_f32 v8, 0xbfb8aa3b, v97
    v_exp_f32 v7, v7
    v_exp_f32 v8, v8
    v_add_f32 v7, 1.0, v7
    v_add_f32 v8, 1.0, v8
    v_rcp_f32 v7, v7
    v_rcp_f32 v8, v8
    v_mul_f32 v7, v7, v96
    v_mul_f32 v8, v8, v97
    v_cvt_pk_bf16_f32 v106, v7, v8
    v_cvt_pk_bf16_f32 v6, v98, v99
    v_lshlrev_b32 v98, 16, v6
    v_and_b32 v99, s22, v6
    v_mul_f32 v9, 0xbfb8aa3b, v98
    v_mul_f32 v10, 0xbfb8aa3b, v99
    v_exp_f32 v9, v9
    v_exp_f32 v10, v10
    v_add_f32 v9, 1.0, v9
    v_add_f32 v10, 1.0, v10
    v_rcp_f32 v9, v9
    v_rcp_f32 v10, v10
    v_mul_f32 v9, v9, v98
    v_mul_f32 v10, v10, v99
    v_cvt_pk_bf16_f32 v107, v9, v10
    s_waitcnt lgkmcnt(0)
    v_mfma_f32_16x16x32_bf16 v[84:87], v[52:55], v[100:103], 0
    v_mfma_f32_16x16x32_bf16 v[88:91], v[60:63], v[100:103], 0
    v_mfma_f32_16x16x32_bf16 v[92:95], v[68:71], v[100:103], 0
    v_mfma_f32_16x16x32_bf16 v[96:99], v[76:79], v[100:103], 0
    v_mfma_f32_16x16x32_bf16 v[84:87], v[56:59], v[104:107], v[84:87]
    v_mfma_f32_16x16x32_bf16 v[88:91], v[64:67], v[104:107], v[88:91]
    v_mfma_f32_16x16x32_bf16 v[92:95], v[72:75], v[104:107], v[92:95]
    v_mfma_f32_16x16x32_bf16 v[96:99], v[80:83], v[104:107], v[96:99]
    s_waitcnt vmcnt(0)
    v_lshl_add_u32 v18, v15, 5, v17
    s_nop 2
    v_cvt_pk_bf16_f32 v6, v84, v85
    v_lshlrev_b32 v84, 16, v6
    v_and_b32 v85, s22, v6
    v_cvt_pk_bf16_f32 v6, v86, v87
    v_lshlrev_b32 v86, 16, v6
    v_and_b32 v87, s22, v6
    v_lshlrev_b32 v7, 16, v28
    v_and_b32 v8, s22, v28
    v_mul_f32 v7, v7, v84
    v_mul_f32 v8, v8, v85
    v_cvt_pk_bf16_f32 v52, v7, v8
    v_lshlrev_b32 v9, 16, v29
    v_and_b32 v10, s22, v29
    v_mul_f32 v9, v9, v86
    v_mul_f32 v10, v10, v87
    v_cvt_pk_bf16_f32 v53, v9, v10
    v_lshlrev_b32 v7, 16, v36
    v_and_b32 v8, s22, v36
    v_mul_f32 v7, v7, v84
    v_mul_f32 v8, v8, v85
    v_cvt_pk_bf16_f32 v54, v7, v8
    v_lshlrev_b32 v9, 16, v37
    v_and_b32 v10, s22, v37
    v_mul_f32 v9, v9, v86
    v_mul_f32 v10, v10, v87
    v_cvt_pk_bf16_f32 v55, v9, v10
    v_lshlrev_b32 v7, 16, v44
    v_and_b32 v8, s22, v44
    v_mul_f32 v7, v7, v84
    v_mul_f32 v8, v8, v85
    v_cvt_pk_bf16_f32 v56, v7, v8
    v_lshlrev_b32 v9, 16, v45
    v_and_b32 v10, s22, v45
    v_mul_f32 v9, v9, v86
    v_mul_f32 v10, v10, v87
    v_cvt_pk_bf16_f32 v57, v9, v10
    v_mov_b32 v58, v100
    v_mov_b32 v59, v101
    buffer_store_dwordx4 v[52:55], v18, s[36:39], 0 offen offset:0
    buffer_store_dwordx4 v[56:59], v18, s[36:39], 0 offen offset:256
    v_cvt_pk_bf16_f32 v6, v88, v89
    v_lshlrev_b32 v88, 16, v6
    v_and_b32 v89, s22, v6
    v_cvt_pk_bf16_f32 v6, v90, v91
    v_lshlrev_b32 v90, 16, v6
    v_and_b32 v91, s22, v6
    v_lshlrev_b32 v7, 16, v30
    v_and_b32 v8, s22, v30
    v_mul_f32 v7, v7, v88
    v_mul_f32 v8, v8, v89
    v_cvt_pk_bf16_f32 v60, v7, v8
    v_lshlrev_b32 v9, 16, v31
    v_and_b32 v10, s22, v31
    v_mul_f32 v9, v9, v90
    v_mul_f32 v10, v10, v91
    v_cvt_pk_bf16_f32 v61, v9, v10
    v_lshlrev_b32 v7, 16, v38
    v_and_b32 v8, s22, v38
    v_mul_f32 v7, v7, v88
    v_mul_f32 v8, v8, v89
    v_cvt_pk_bf16_f32 v62, v7, v8
    v_lshlrev_b32 v9, 16, v39
    v_and_b32 v10, s22, v39
    v_mul_f32 v9, v9, v90
    v_mul_f32 v10, v10, v91
    v_cvt_pk_bf16_f32 v63, v9, v10
    v_lshlrev_b32 v7, 16, v46
    v_and_b32 v8, s22, v46
    v_mul_f32 v7, v7, v88
    v_mul_f32 v8, v8, v89
    v_cvt_pk_bf16_f32 v64, v7, v8
    v_lshlrev_b32 v9, 16, v47
    v_and_b32 v10, s22, v47
    v_mul_f32 v9, v9, v90
    v_mul_f32 v10, v10, v91
    v_cvt_pk_bf16_f32 v65, v9, v10
    v_mov_b32 v66, v102
    v_mov_b32 v67, v103
    buffer_store_dwordx4 v[60:63], v18, s[36:39], 0 offen offset:16
    buffer_store_dwordx4 v[64:67], v18, s[36:39], 0 offen offset:272
    v_cvt_pk_bf16_f32 v6, v92, v93
    v_lshlrev_b32 v92, 16, v6
    v_and_b32 v93, s22, v6
    v_cvt_pk_bf16_f32 v6, v94, v95
    v_lshlrev_b32 v94, 16, v6
    v_and_b32 v95, s22, v6
    v_lshlrev_b32 v7, 16, v32
    v_and_b32 v8, s22, v32
    v_mul_f32 v7, v7, v92
    v_mul_f32 v8, v8, v93
    v_cvt_pk_bf16_f32 v68, v7, v8
    v_lshlrev_b32 v9, 16, v33
    v_and_b32 v10, s22, v33
    v_mul_f32 v9, v9, v94
    v_mul_f32 v10, v10, v95
    v_cvt_pk_bf16_f32 v69, v9, v10
    v_lshlrev_b32 v7, 16, v40
    v_and_b32 v8, s22, v40
    v_mul_f32 v7, v7, v92
    v_mul_f32 v8, v8, v93
    v_cvt_pk_bf16_f32 v70, v7, v8
    v_lshlrev_b32 v9, 16, v41
    v_and_b32 v10, s22, v41
    v_mul_f32 v9, v9, v94
    v_mul_f32 v10, v10, v95
    v_cvt_pk_bf16_f32 v71, v9, v10
    v_lshlrev_b32 v7, 16, v48
    v_and_b32 v8, s22, v48
    v_mul_f32 v7, v7, v92
    v_mul_f32 v8, v8, v93
    v_cvt_pk_bf16_f32 v72, v7, v8
    v_lshlrev_b32 v9, 16, v49
    v_and_b32 v10, s22, v49
    v_mul_f32 v9, v9, v94
    v_mul_f32 v10, v10, v95
    v_cvt_pk_bf16_f32 v73, v9, v10
    v_mov_b32 v74, v104
    v_mov_b32 v75, v105
    buffer_store_dwordx4 v[68:71], v18, s[36:39], 0 offen offset:128
    buffer_store_dwordx4 v[72:75], v18, s[36:39], 0 offen offset:384
    v_cvt_pk_bf16_f32 v6, v96, v97
    v_lshlrev_b32 v96, 16, v6
    v_and_b32 v97, s22, v6
    v_cvt_pk_bf16_f32 v6, v98, v99
    v_lshlrev_b32 v98, 16, v6
    v_and_b32 v99, s22, v6
    v_lshlrev_b32 v7, 16, v34
    v_and_b32 v8, s22, v34
    v_mul_f32 v7, v7, v96
    v_mul_f32 v8, v8, v97
    v_cvt_pk_bf16_f32 v76, v7, v8
    v_lshlrev_b32 v9, 16, v35
    v_and_b32 v10, s22, v35
    v_mul_f32 v9, v9, v98
    v_mul_f32 v10, v10, v99
    v_cvt_pk_bf16_f32 v77, v9, v10
    v_lshlrev_b32 v7, 16, v42
    v_and_b32 v8, s22, v42
    v_mul_f32 v7, v7, v96
    v_mul_f32 v8, v8, v97
    v_cvt_pk_bf16_f32 v78, v7, v8
    v_lshlrev_b32 v9, 16, v43
    v_and_b32 v10, s22, v43
    v_mul_f32 v9, v9, v98
    v_mul_f32 v10, v10, v99
    v_cvt_pk_bf16_f32 v79, v9, v10
    v_lshlrev_b32 v7, 16, v50
    v_and_b32 v8, s22, v50
    v_mul_f32 v7, v7, v96
    v_mul_f32 v8, v8, v97
    v_cvt_pk_bf16_f32 v80, v7, v8
    v_lshlrev_b32 v9, 16, v51
    v_and_b32 v10, s22, v51
    v_mul_f32 v9, v9, v98
    v_mul_f32 v10, v10, v99
    v_cvt_pk_bf16_f32 v81, v9, v10
    v_mov_b32 v82, v106
    v_mov_b32 v83, v107
    buffer_store_dwordx4 v[76:79], v18, s[36:39], 0 offen offset:144
    buffer_store_dwordx4 v[80:83], v18, s[36:39], 0 offen offset:400
    s_endpgm
K1_CONST:
    s_cmp_eq_u32 s2, 197
    s_cbranch_scc1 K1_GT
    s_mov_b32 s28, s18
    s_and_b32 s29, s19, 0xffff
    s_mov_b32 s30, 6144
    s_mov_b32 s31, 0x20000
    s_mov_b32 s32, s16
    s_and_b32 s33, s17, 0xffff
    s_mov_b32 s34, 24576
    s_mov_b32 s35, 0x20000
    s_add_u32 s36, s20, 6422528
    s_addc_u32 s37, s21, 0
    s_and_b32 s37, s37, 0xffff
    s_mov_b32 s38, 28672
    s_mov_b32 s39, 0x20000
    v_and_b32 v1, 63, v0
    v_and_b32 v2, 15, v1
    v_lshrrev_b32 v3, 4, v1
    v_bfe_u32 v4, v0, 6, 2
    v_bfe_u32 v5, v0, 8, 1
    v_lshlrev_b32 v6, 4, v3
    v_lshl_add_u32 v6, v5, 1, v6
    v_mul_u32_u24 v6, 384, v6
    v_lshl_add_u32 v7, v2, 2, v4
    v_lshl_add_u32 v6, v7, 1, v6
    v_add_u32 v8, 0, v6
    buffer_load_ushort v16, v8, s[32:35], 0 offen
    v_add_u32 v8, 1536, v6
    buffer_load_ushort v17, v8, s[32:35], 0 offen
    v_add_u32 v8, 3072, v6
    buffer_load_ushort v18, v8, s[32:35], 0 offen
    v_add_u32 v8, 4608, v6
    buffer_load_ushort v19, v8, s[32:35], 0 offen
    v_add_u32 v8, 384, v6
    buffer_load_ushort v20, v8, s[32:35], 0 offen
    v_add_u32 v8, 1920, v6
    buffer_load_ushort v21, v8, s[32:35], 0 offen
    v_add_u32 v8, 3456, v6
    buffer_load_ushort v22, v8, s[32:35], 0 offen
    v_add_u32 v8, 4992, v6
    buffer_load_ushort v23, v8, s[32:35], 0 offen
    v_add_u32 v8, 256, v6
    buffer_load_ushort v24, v8, s[32:35], 0 offen
    v_add_u32 v8, 1792, v6
    buffer_load_ushort v25, v8, s[32:35], 0 offen
    v_add_u32 v8, 3328, v6
    buffer_load_ushort v26, v8, s[32:35], 0 offen
    v_add_u32 v8, 4864, v6
    buffer_load_ushort v27, v8, s[32:35], 0 offen
    v_add_u32 v8, 640, v6
    buffer_load_ushort v28, v8, s[32:35], 0 offen
    v_add_u32 v8, 2176, v6
    buffer_load_ushort v29, v8, s[32:35], 0 offen
    v_add_u32 v8, 3712, v6
    buffer_load_ushort v30, v8, s[32:35], 0 offen
    v_add_u32 v8, 5248, v6
    buffer_load_ushort v31, v8, s[32:35], 0 offen
    v_lshlrev_b32 v9, 2, v3
    v_mul_u32_u24 v9, 384, v9
    v_lshl_add_u32 v9, v7, 1, v9
    v_lshl_add_u32 v10, v5, 7, v9
    buffer_load_ushort v32, v10, s[28:31], 0 offen offset:0
    buffer_load_ushort v33, v10, s[28:31], 0 offen offset:384
    buffer_load_ushort v34, v10, s[28:31], 0 offen offset:768
    buffer_load_ushort v35, v10, s[28:31], 0 offen offset:1152
    buffer_load_ushort v36, v9, s[28:31], 0 offen offset:256
    buffer_load_ushort v37, v9, s[28:31], 0 offen offset:640
    buffer_load_ushort v38, v9, s[28:31], 0 offen offset:1024
    buffer_load_ushort v39, v9, s[28:31], 0 offen offset:1408
    s_waitcnt vmcnt(0)
    v_lshlrev_b32 v11, 4, v0
    v_lshl_or_b32 v40, v17, 16, v16
    v_lshl_or_b32 v41, v19, 16, v18
    v_lshl_or_b32 v42, v21, 16, v20
    v_lshl_or_b32 v43, v23, 16, v22
    buffer_store_dwordx4 v[40:43], v11, s[36:39], 0 offen
    v_lshl_or_b32 v44, v25, 16, v24
    v_lshl_or_b32 v45, v27, 16, v26
    v_lshl_or_b32 v46, v29, 16, v28
    v_lshl_or_b32 v47, v31, 16, v30
    v_add_u32 v12, 8192, v11
    buffer_store_dwordx4 v[44:47], v12, s[36:39], 0 offen
    v_lshlrev_b32 v32, 16, v32
    v_lshlrev_b32 v33, 16, v33
    v_lshlrev_b32 v34, 16, v34
    v_lshlrev_b32 v35, 16, v35
    v_lshlrev_b32 v36, 16, v36
    v_lshlrev_b32 v37, 16, v37
    v_lshlrev_b32 v38, 16, v38
    v_lshlrev_b32 v39, 16, v39
    v_add_u32 v12, 16384, v11
    buffer_store_dwordx4 v[32:35], v12, s[36:39], 0 offen
    v_cmp_gt_u32 vcc, 256, v0
    s_nop 0
    s_and_saveexec_b64 s[44:45], vcc
    v_add_u32 v12, 24576, v11
    buffer_store_dwordx4 v[36:39], v12, s[36:39], 0 offen
    s_endpgm
K1_GT:
    s_add_u32 s36, s20, 6455296
    s_addc_u32 s37, s21, 0
    s_and_b32 s37, s37, 0xffff
    s_mov_b32 s38, 25632
    s_mov_b32 s39, 0x20000
    s_load_dwordx8 s[24:31], s[12:13], 0
    s_waitcnt lgkmcnt(0)
    v_add_u32 v1, 0, v0
    v_add_u32 v2, 15743, v1
    v_lshlrev_b32 v2, 16, v2
    v_rcp_f32 v3, v2
    v_mul_f32 v4, 0x40490fdb, v2
    v_cvt_pk_bf16_f32 v4, v4, v4
    v_and_b32 v4, s22, v4
    v_mul_f32 v4, 0x3e4ccccd, v4
    v_cvt_pk_bf16_f32 v4, v4, v4
    v_and_b32 v4, s22, v4
    v_mul_f32 v4, 0.15915494, v4
    v_cos_f32 v4, v4
    s_nop 0
    v_cvt_pk_bf16_f32 v4, v4, v4
    v_and_b32 v4, s22, v4
    v_add_f32 v4, 1.0, v4
    v_cvt_pk_bf16_f32 v4, v4, v4
    v_and_b32 v4, s22, v4
    v_mul_f32 v3, 0.5, v3
    v_mul_f32 v4, v4, v3
    v_cmp_eq_u32 vcc, 0, v1
    v_mov_b32 v5, 0
    s_nop 0
    v_cndmask_b32 v4, v4, v5, vcc
    v_cndmask_b32 v2, v2, v5, vcc
    s_lshl_b32 s4, s24, 16
    s_and_b32 s5, s24, s22
    v_mul_f32 v6, s4, v2
    v_mul_f32 v7, s5, v2
    v_cvt_pk_bf16_f32 v8, v6, v7
    v_lshlrev_b32 v6, 16, v8
    v_and_b32 v7, s22, v8
    v_mul_f32 v6, 0.15915494, v6
    v_mul_f32 v7, 0.15915494, v7
    v_sin_f32 v6, v6
    v_sin_f32 v7, v7
    v_mul_f32 v6, v6, v4
    v_mul_f32 v7, v7, v4
    v_cvt_pk_bf16_f32 v16, v6, v7
    s_lshl_b32 s4, s25, 16
    s_and_b32 s5, s25, s22
    v_mul_f32 v6, s4, v2
    v_mul_f32 v7, s5, v2
    v_cvt_pk_bf16_f32 v8, v6, v7
    v_lshlrev_b32 v6, 16, v8
    v_and_b32 v7, s22, v8
    v_mul_f32 v6, 0.15915494, v6
    v_mul_f32 v7, 0.15915494, v7
    v_sin_f32 v6, v6
    v_sin_f32 v7, v7
    v_mul_f32 v6, v6, v4
    v_mul_f32 v7, v7, v4
    v_cvt_pk_bf16_f32 v17, v6, v7
    s_lshl_b32 s4, s26, 16
    s_and_b32 s5, s26, s22
    v_mul_f32 v6, s4, v2
    v_mul_f32 v7, s5, v2
    v_cvt_pk_bf16_f32 v8, v6, v7
    v_lshlrev_b32 v6, 16, v8
    v_and_b32 v7, s22, v8
    v_mul_f32 v6, 0.15915494, v6
    v_mul_f32 v7, 0.15915494, v7
    v_sin_f32 v6, v6
    v_sin_f32 v7, v7
    v_mul_f32 v6, v6, v4
    v_mul_f32 v7, v7, v4
    v_cvt_pk_bf16_f32 v18, v6, v7
    s_lshl_b32 s4, s27, 16
    s_and_b32 s5, s27, s22
    v_mul_f32 v6, s4, v2
    v_mul_f32 v7, s5, v2
    v_cvt_pk_bf16_f32 v8, v6, v7
    v_lshlrev_b32 v6, 16, v8
    v_and_b32 v7, s22, v8
    v_mul_f32 v6, 0.15915494, v6
    v_mul_f32 v7, 0.15915494, v7
    v_sin_f32 v6, v6
    v_sin_f32 v7, v7
    v_mul_f32 v6, v6, v4
    v_mul_f32 v7, v7, v4
    v_cvt_pk_bf16_f32 v19, v6, v7
    s_lshl_b32 s4, s28, 16
    s_and_b32 s5, s28, s22
    v_mul_f32 v6, s4, v2
    v_mul_f32 v7, s5, v2
    v_cvt_pk_bf16_f32 v8, v6, v7
    v_lshlrev_b32 v6, 16, v8
    v_and_b32 v7, s22, v8
    v_mul_f32 v6, 0.15915494, v6
    v_mul_f32 v7, 0.15915494, v7
    v_sin_f32 v6, v6
    v_sin_f32 v7, v7
    v_mul_f32 v6, v6, v4
    v_mul_f32 v7, v7, v4
    v_cvt_pk_bf16_f32 v20, v6, v7
    s_lshl_b32 s4, s29, 16
    s_and_b32 s5, s29, s22
    v_mul_f32 v6, s4, v2
    v_mul_f32 v7, s5, v2
    v_cvt_pk_bf16_f32 v8, v6, v7
    v_lshlrev_b32 v6, 16, v8
    v_and_b32 v7, s22, v8
    v_mul_f32 v6, 0.15915494, v6
    v_mul_f32 v7, 0.15915494, v7
    v_sin_f32 v6, v6
    v_sin_f32 v7, v7
    v_mul_f32 v6, v6, v4
    v_mul_f32 v7, v7, v4
    v_cvt_pk_bf16_f32 v21, v6, v7
    s_lshl_b32 s4, s30, 16
    s_and_b32 s5, s30, s22
    v_mul_f32 v6, s4, v2
    v_mul_f32 v7, s5, v2
    v_cvt_pk_bf16_f32 v8, v6, v7
    v_lshlrev_b32 v6, 16, v8
    v_and_b32 v7, s22, v8
    v_mul_f32 v6, 0.15915494, v6
    v_mul_f32 v7, 0.15915494, v7
    v_sin_f32 v6, v6
    v_sin_f32 v7, v7
    v_mul_f32 v6, v6, v4
    v_mul_f32 v7, v7, v4
    v_cvt_pk_bf16_f32 v22, v6, v7
    s_lshl_b32 s4, s31, 16
    s_and_b32 s5, s31, s22
    v_mul_f32 v6, s4, v2
    v_mul_f32 v7, s5, v2
    v_cvt_pk_bf16_f32 v8, v6, v7
    v_lshlrev_b32 v6, 16, v8
    v_and_b32 v7, s22, v8
    v_mul_f32 v6, 0.15915494, v6
    v_mul_f32 v7, 0.15915494, v7
    v_sin_f32 v6, v6
    v_sin_f32 v7, v7
    v_mul_f32 v6, v6, v4
    v_mul_f32 v7, v7, v4
    v_cvt_pk_bf16_f32 v23, v6, v7
    v_lshlrev_b32 v9, 5, v1
    buffer_store_dwordx4 v[16:19], v9, s[36:39], 0 offen
    buffer_store_dwordx4 v[20:23], v9, s[36:39], 0 offen offset:16
    s_nop 2
    v_add_u32 v1, 512, v0
    v_add_u32 v2, 15743, v1
    v_lshlrev_b32 v2, 16, v2
    v_rcp_f32 v3, v2
    v_mul_f32 v4, 0x40490fdb, v2
    v_cvt_pk_bf16_f32 v4, v4, v4
    v_and_b32 v4, s22, v4
    v_mul_f32 v4, 0x3e4ccccd, v4
    v_cvt_pk_bf16_f32 v4, v4, v4
    v_and_b32 v4, s22, v4
    v_mul_f32 v4, 0.15915494, v4
    v_cos_f32 v4, v4
    s_nop 0
    v_cvt_pk_bf16_f32 v4, v4, v4
    v_and_b32 v4, s22, v4
    v_add_f32 v4, 1.0, v4
    v_cvt_pk_bf16_f32 v4, v4, v4
    v_and_b32 v4, s22, v4
    v_mul_f32 v3, 0.5, v3
    v_mul_f32 v4, v4, v3
    v_cmp_eq_u32 vcc, 0, v1
    v_mov_b32 v5, 0
    s_nop 0
    v_cndmask_b32 v4, v4, v5, vcc
    v_cndmask_b32 v2, v2, v5, vcc
    s_lshl_b32 s4, s24, 16
    s_and_b32 s5, s24, s22
    v_mul_f32 v6, s4, v2
    v_mul_f32 v7, s5, v2
    v_cvt_pk_bf16_f32 v8, v6, v7
    v_lshlrev_b32 v6, 16, v8
    v_and_b32 v7, s22, v8
    v_mul_f32 v6, 0.15915494, v6
    v_mul_f32 v7, 0.15915494, v7
    v_sin_f32 v6, v6
    v_sin_f32 v7, v7
    v_mul_f32 v6, v6, v4
    v_mul_f32 v7, v7, v4
    v_cvt_pk_bf16_f32 v16, v6, v7
    s_lshl_b32 s4, s25, 16
    s_and_b32 s5, s25, s22
    v_mul_f32 v6, s4, v2
    v_mul_f32 v7, s5, v2
    v_cvt_pk_bf16_f32 v8, v6, v7
    v_lshlrev_b32 v6, 16, v8
    v_and_b32 v7, s22, v8
    v_mul_f32 v6, 0.15915494, v6
    v_mul_f32 v7, 0.15915494, v7
    v_sin_f32 v6, v6
    v_sin_f32 v7, v7
    v_mul_f32 v6, v6, v4
    v_mul_f32 v7, v7, v4
    v_cvt_pk_bf16_f32 v17, v6, v7
    s_lshl_b32 s4, s26, 16
    s_and_b32 s5, s26, s22
    v_mul_f32 v6, s4, v2
    v_mul_f32 v7, s5, v2
    v_cvt_pk_bf16_f32 v8, v6, v7
    v_lshlrev_b32 v6, 16, v8
    v_and_b32 v7, s22, v8
    v_mul_f32 v6, 0.15915494, v6
    v_mul_f32 v7, 0.15915494, v7
    v_sin_f32 v6, v6
    v_sin_f32 v7, v7
    v_mul_f32 v6, v6, v4
    v_mul_f32 v7, v7, v4
    v_cvt_pk_bf16_f32 v18, v6, v7
    s_lshl_b32 s4, s27, 16
    s_and_b32 s5, s27, s22
    v_mul_f32 v6, s4, v2
    v_mul_f32 v7, s5, v2
    v_cvt_pk_bf16_f32 v8, v6, v7
    v_lshlrev_b32 v6, 16, v8
    v_and_b32 v7, s22, v8
    v_mul_f32 v6, 0.15915494, v6
    v_mul_f32 v7, 0.15915494, v7
    v_sin_f32 v6, v6
    v_sin_f32 v7, v7
    v_mul_f32 v6, v6, v4
    v_mul_f32 v7, v7, v4
    v_cvt_pk_bf16_f32 v19, v6, v7
    s_lshl_b32 s4, s28, 16
    s_and_b32 s5, s28, s22
    v_mul_f32 v6, s4, v2
    v_mul_f32 v7, s5, v2
    v_cvt_pk_bf16_f32 v8, v6, v7
    v_lshlrev_b32 v6, 16, v8
    v_and_b32 v7, s22, v8
    v_mul_f32 v6, 0.15915494, v6
    v_mul_f32 v7, 0.15915494, v7
    v_sin_f32 v6, v6
    v_sin_f32 v7, v7
    v_mul_f32 v6, v6, v4
    v_mul_f32 v7, v7, v4
    v_cvt_pk_bf16_f32 v20, v6, v7
    s_lshl_b32 s4, s29, 16
    s_and_b32 s5, s29, s22
    v_mul_f32 v6, s4, v2
    v_mul_f32 v7, s5, v2
    v_cvt_pk_bf16_f32 v8, v6, v7
    v_lshlrev_b32 v6, 16, v8
    v_and_b32 v7, s22, v8
    v_mul_f32 v6, 0.15915494, v6
    v_mul_f32 v7, 0.15915494, v7
    v_sin_f32 v6, v6
    v_sin_f32 v7, v7
    v_mul_f32 v6, v6, v4
    v_mul_f32 v7, v7, v4
    v_cvt_pk_bf16_f32 v21, v6, v7
    s_lshl_b32 s4, s30, 16
    s_and_b32 s5, s30, s22
    v_mul_f32 v6, s4, v2
    v_mul_f32 v7, s5, v2
    v_cvt_pk_bf16_f32 v8, v6, v7
    v_lshlrev_b32 v6, 16, v8
    v_and_b32 v7, s22, v8
    v_mul_f32 v6, 0.15915494, v6
    v_mul_f32 v7, 0.15915494, v7
    v_sin_f32 v6, v6
    v_sin_f32 v7, v7
    v_mul_f32 v6, v6, v4
    v_mul_f32 v7, v7, v4
    v_cvt_pk_bf16_f32 v22, v6, v7
    s_lshl_b32 s4, s31, 16
    s_and_b32 s5, s31, s22
    v_mul_f32 v6, s4, v2
    v_mul_f32 v7, s5, v2
    v_cvt_pk_bf16_f32 v8, v6, v7
    v_lshlrev_b32 v6, 16, v8
    v_and_b32 v7, s22, v8
    v_mul_f32 v6, 0.15915494, v6
    v_mul_f32 v7, 0.15915494, v7
    v_sin_f32 v6, v6
    v_sin_f32 v7, v7
    v_mul_f32 v6, v6, v4
    v_mul_f32 v7, v7, v4
    v_cvt_pk_bf16_f32 v23, v6, v7
    v_lshlrev_b32 v9, 5, v1
    buffer_store_dwordx4 v[16:19], v9, s[36:39], 0 offen
    buffer_store_dwordx4 v[20:23], v9, s[36:39], 0 offen offset:16
    s_nop 2
K1_END:
    s_endpgm
.globl k2_kernel
.p2align 8
.type k2_kernel,@function
k2_kernel:
    s_load_dwordx4 s[4:7], s[0:1], 0
    s_load_dwordx2 s[96:97], s[0:1], 32
    s_load_dwordx2 s[8:9], s[0:1], 64
    s_load_dwordx2 s[10:11], s[0:1], 80
    s_cmp_ge_u32 s2, 256
    s_cbranch_scc1 K2_END
    s_mov_b32 s28, 0xffff0000
    s_mov_b32 s29, 0x05040100
    s_mov_b32 s30, 0x07060302
    s_mov_b32 s31, 512
    s_and_b32 s91, s2, 7
    s_lshl_b32 s91, s91, 5
    s_lshr_b32 s52, s2, 3
    s_or_b32 s91, s91, s52
    s_mul_i32 s32, s91, 12500
    s_add_u32 s33, s32, 12755
    s_add_u32 s32, s32, 255
    s_lshr_b32 s32, s32, 8
    s_lshr_b32 s33, s33, 8
    s_sub_u32 s33, s33, s32
    v_and_b32 v22, 63, v0
    v_and_b32 v14, 15, v22
    v_lshrrev_b32 v15, 4, v22
    v_lshlrev_b32 v1, 4, v14
    v_lshrrev_b32 v16, 6, v0
    s_nop 0
    v_readfirstlane_b32 s43, v16
    v_lshlrev_b32 v4, 4, v15
    v_lshl_add_u32 v7, v14, 2, v15
    v_lshlrev_b32 v7, 1, v7
    v_lshlrev_b32 v12, 4, v22
    v_add_u32 v12, 104960, v12
    s_mul_i32 s79, s43, 2048
    s_add_u32 s79, s79, 88576
    v_mov_b32 v23, s79
    v_lshrrev_b32 v3, 2, v14
    v_lshl_add_u32 v3, v15, 3, v3
    v_lshl_add_u32 v3, v3, 2, v23
    v_and_b32 v254, 3, v22
    v_lshlrev_b32 v254, 3, v254
    v_lshlrev_b32 v20, 5, v15
    v_add_u32 v20, v20, v23
    v_mov_b32 v2, 0
    v_lshlrev_b32 v14, 1, v14
    s_waitcnt lgkmcnt(0)
    s_mov_b32 s16, s10
    s_and_b32 s17, s11, 0xffff
    s_mov_b32 s18, 33816576
    s_mov_b32 s19, 0x20000
    v_lshl_add_u32 v17, v16, 5, v22
    v_cmp_gt_u32 vcc, 32, v22
    v_mov_b32 v248, 0
    v_mov_b32 v18, 250
    v_cmp_lt_u32 s[52:53], v17, v18
    s_nop 0
    s_and_b64 vcc, vcc, s[52:53]
    v_lshlrev_b32 v18, 2, v17
    s_lshl_b32 s52, s91, 10
    s_add_u32 s52, s52, 6488064
    s_and_saveexec_b64 s[50:51], vcc
    buffer_load_dword v248, v18, s[16:19], s52 offen
    s_mov_b64 exec, s[50:51]
    s_mov_b32 s12, s10
    s_and_b32 s13, s11, 0xffff
    s_mov_b32 s14, 6400000
    s_mov_b32 s15, 0x20000
    s_mov_b32 s20, s4
    s_and_b32 s21, s5, 0xffff
    s_mov_b32 s22, 6400000
    s_mov_b32 s23, 0x20000
    s_mov_b32 s24, s8
    s_and_b32 s25, s9, 0xffff
    s_mov_b32 s26, 6400000
    s_mov_b32 s27, 0x20000
    s_mov_b32 s80, s6
    s_and_b32 s81, s7, 0xffff
    s_mov_b32 s82, 75000
    s_mov_b32 s83, 0x20000
    global_load_short_d16_hi v2, v14, s[96:97]
    s_mov_b32 s44, 0
    s_mov_b32 s45, 512
    s_mov_b32 s48, 1
    v_mul_u32_u24 v249, 3200, v17
    s_cmp_eq_u32 s48, 1
    s_cbranch_scc0 K2_XD_P1
    v_lshlrev_b32 v35, 4, v22
    s_mul_i32 s52, s2, 9
    s_add_u32 s52, s52, s43
    s_add_u32 s52, s52, 0
    s_mul_hi_u32 s53, s52, 58040099
    s_mul_i32 s53, s53, 74
    s_sub_u32 s52, s52, s53
    s_lshl_b32 s52, s52, 10
    s_add_u32 m0, s52, 12800
    s_add_u32 s53, s52, 8192
    buffer_load_dwordx4 v35, s[80:83], s52 offen lds
    s_sub_u32 s52, s53, 75776
    s_cmp_lt_u32 s53, 75776
    s_cselect_b32 s52, s53, s52
    s_add_u32 m0, s52, 12800
    s_add_u32 s53, s52, 8192
    buffer_load_dwordx4 v35, s[80:83], s52 offen lds
    s_sub_u32 s52, s53, 75776
    s_cmp_lt_u32 s53, 75776
    s_cselect_b32 s52, s53, s52
    s_add_u32 m0, s52, 12800
    s_nop 0
    buffer_load_dwordx4 v35, s[80:83], s52 offen lds
K2_XD_P1:
    s_waitcnt vmcnt(4)
    v_and_b32 v18, 0xffff, v248
    v_add_u32 v249, v249, v18
    v_lshrrev_b32 v248, 16, v248
    v_mov_b32 v253, v248
    s_nop 1
    v_add_u32_dpp v253, v253, v253 row_shr:1 row_mask:0xf bank_mask:0xf
    s_nop 1
    v_add_u32_dpp v253, v253, v253 row_shr:2 row_mask:0xf bank_mask:0xf
    s_nop 1
    v_add_u32_dpp v253, v253, v253 row_shr:4 row_mask:0xf bank_mask:0xf
    s_nop 1
    v_add_u32_dpp v253, v253, v253 row_shr:8 row_mask:0xf bank_mask:0xf
    s_nop 1
    v_add_u32_dpp v253, v253, v253 row_bcast:15 row_mask:0xa bank_mask:0xf
    s_nop 0
    v_readlane_b32 s46, v253, 31
    v_sub_u32 v253, v253, v248
    s_branch K2_ROUND_IN
K2_ROUND:
    s_barrier
K2_ROUND_IN:
    v_lshlrev_b32 v18, 4, v0
    v_mov_b32 v24, 0
    v_mov_b32 v25, 0
    v_mov_b32 v26, 0
    v_mov_b32 v27, 0
    v_add_u32 v19, 160256, v18
    v_cmp_gt_u32 vcc, 24, v0
    s_nop 0
    s_and_saveexec_b64 s[50:51], vcc
    ds_write_b128 v19, v[24:27]
    s_mov_b64 exec, s[50:51]
    v_mov_b32 v24, 1879076864
    v_mov_b32 v25, v24
    v_mov_b32 v26, v24
    v_mov_b32 v27, v24
    ds_write_b128 v18, v[24:27]
    v_cmp_gt_u32 vcc, 276, v0
    s_nop 0
    s_and_saveexec_b64 s[50:51], vcc
    ds_write_b128 v18, v[24:27] offset:8192
    s_mov_b64 exec, s[50:51]
    v_subrev_u32 v30, s44, v253
    v_sub_u32 v31, 0, v30
    v_max_i32 v31, 0, v31
    v_sub_u32 v32, s45, v30
    v_min_i32 v32, v32, v248
    v_add_u32 v33, v30, v31
    v_lshlrev_b32 v33, 2, v33
    v_add_u32 v33, s79, v33
    v_add_lshl_u32 v28, v249, v31, 2
    v_sub_u32 v32, v32, v31
K2_MK:
    v_cmp_lt_i32 vcc, 0, v32
    s_cbranch_vccz K2_MK_DONE
    s_and_saveexec_b64 s[50:51], vcc
    ds_write_b32 v33, v28
    v_add_u32 v29, 4, v28
    v_cmp_lt_i32 vcc, 1, v32
    s_nop 0
    s_and_b64 exec, exec, vcc
    ds_write_b32 v33, v29 offset:4
    s_mov_b64 exec, s[50:51]
    v_add_u32 v33, 8, v33
    v_add_u32 v28, 8, v28
    v_subrev_u32 v32, 2, v32
    s_branch K2_MK
K2_MK_DONE:
    s_cmp_eq_u32 s48, 1
    s_cbranch_scc0 K2_XD_P2
    v_lshlrev_b32 v35, 4, v22
    s_mul_i32 s52, s2, 9
    s_add_u32 s52, s52, s43
    s_add_u32 s52, s52, 24
    s_mul_hi_u32 s53, s52, 58040099
    s_mul_i32 s53, s53, 74
    s_sub_u32 s52, s52, s53
    s_lshl_b32 s52, s52, 10
    s_add_u32 m0, s52, 12800
    s_add_u32 s53, s52, 8192
    buffer_load_dwordx4 v35, s[80:83], s52 offen lds
    s_sub_u32 s52, s53, 75776
    s_cmp_lt_u32 s53, 75776
    s_cselect_b32 s52, s53, s52
    s_add_u32 m0, s52, 12800
    s_add_u32 s53, s52, 8192
    buffer_load_dwordx4 v35, s[80:83], s52 offen lds
    s_sub_u32 s52, s53, 75776
    s_cmp_lt_u32 s53, 75776
    s_cselect_b32 s52, s53, s52
    s_add_u32 m0, s52, 12800
    s_nop 0
    buffer_load_dwordx4 v35, s[80:83], s52 offen lds
K2_XD_P2:
    s_sub_i32 s52, s46, s44
    s_max_i32 s52, s52, 0
    s_min_i32 s47, s52, s45
    s_cmp_gt_i32 s52, s45
    s_cselect_b32 s76, 1, 0
    v_lshl_add_u32 v30, v22, 2, v23
    ds_read_b32 v116, v30 offset:0
    ds_read_b32 v117, v30 offset:256
    ds_read_b32 v118, v30 offset:512
    ds_read_b32 v119, v30 offset:768
    ds_read_b32 v120, v30 offset:1024
    ds_read_b32 v121, v30 offset:1280
    ds_read_b32 v122, v30 offset:1536
    ds_read_b32 v123, v30 offset:1792
    s_sub_i32 s52, s47, 0
    v_cmp_gt_i32 s[56:57], s52, v22
    s_sub_i32 s52, s47, 64
    v_cmp_gt_i32 s[58:59], s52, v22
    s_sub_i32 s52, s47, 128
    v_cmp_gt_i32 s[60:61], s52, v22
    s_sub_i32 s52, s47, 192
    v_cmp_gt_i32 s[62:63], s52, v22
    s_sub_i32 s52, s47, 256
    v_cmp_gt_i32 s[64:65], s52, v22
    s_sub_i32 s52, s47, 320
    v_cmp_gt_i32 s[66:67], s52, v22
    s_sub_i32 s52, s47, 384
    v_cmp_gt_i32 s[68:69], s52, v22
    s_sub_i32 s52, s47, 448
    v_cmp_gt_i32 s[70:71], s52, v22
    s_mov_b32 s90, 7340032
    s_mov_b64 s[50:51], exec
    s_waitcnt lgkmcnt(7)
    s_mov_b64 exec, s[56:57]
    buffer_load_dword v136, v116, s[16:19], s90 offen
    s_waitcnt lgkmcnt(6)
    s_mov_b64 exec, s[58:59]
    buffer_load_dword v137, v117, s[16:19], s90 offen
    s_waitcnt lgkmcnt(5)
    s_mov_b64 exec, s[60:61]
    buffer_load_dword v138, v118, s[16:19], s90 offen
    s_waitcnt lgkmcnt(4)
    s_mov_b64 exec, s[62:63]
    buffer_load_dword v139, v119, s[16:19], s90 offen
    s_waitcnt lgkmcnt(3)
    s_mov_b64 exec, s[64:65]
    buffer_load_dword v140, v120, s[16:19], s90 offen
    s_waitcnt lgkmcnt(2)
    s_mov_b64 exec, s[66:67]
    buffer_load_dword v141, v121, s[16:19], s90 offen
    s_waitcnt lgkmcnt(1)
    s_mov_b64 exec, s[68:69]
    buffer_load_dword v142, v122, s[16:19], s90 offen
    s_waitcnt lgkmcnt(0)
    s_mov_b64 exec, s[70:71]
    buffer_load_dword v143, v123, s[16:19], s90 offen
    s_mov_b64 exec, s[50:51]
    s_cmp_eq_u32 s48, 1
    s_cbranch_scc0 K2_XD_C
    v_lshlrev_b32 v35, 4, v22
    s_mul_i32 s55, s2, 5
    s_add_u32 s55, s55, s43
    s_add_u32 s52, s55, 0
    s_mul_hi_u32 s53, s52, 76695845
    s_mul_i32 s53, s53, 56
    s_sub_u32 s52, s52, s53
    s_min_u32 s52, s52, 53
    s_lshl_b32 s53, s52, 10
    s_add_u32 s54, s53, 104960
    s_mov_b32 m0, s54
    s_cmp_ge_u32 s52, 28
    s_mov_b32 s54, 6422528
    s_cselect_b32 s54, 6426624, s54
    s_add_u32 s53, s53, s54
    buffer_load_dwordx4 v35, s[16:19], s53 offen lds
    s_add_u32 s52, s55, 8
    s_mul_hi_u32 s53, s52, 76695845
    s_mul_i32 s53, s53, 56
    s_sub_u32 s52, s52, s53
    s_min_u32 s52, s52, 53
    s_lshl_b32 s53, s52, 10
    s_add_u32 s54, s53, 104960
    s_mov_b32 m0, s54
    s_cmp_ge_u32 s52, 28
    s_mov_b32 s54, 6422528
    s_cselect_b32 s54, 6426624, s54
    s_add_u32 s53, s53, s54
    buffer_load_dwordx4 v35, s[16:19], s53 offen lds
    s_add_u32 s52, s55, 16
    s_mul_hi_u32 s53, s52, 76695845
    s_mul_i32 s53, s53, 56
    s_sub_u32 s52, s52, s53
    s_min_u32 s52, s52, 53
    s_lshl_b32 s53, s52, 10
    s_add_u32 s54, s53, 104960
    s_mov_b32 m0, s54
    s_cmp_ge_u32 s52, 28
    s_mov_b32 s54, 6422528
    s_cselect_b32 s54, 6426624, s54
    s_add_u32 s53, s53, s54
    buffer_load_dwordx4 v35, s[16:19], s53 offen lds
    s_add_u32 s52, s55, 24
    s_mul_hi_u32 s53, s52, 76695845
    s_mul_i32 s53, s53, 56
    s_sub_u32 s52, s52, s53
    s_min_u32 s52, s52, 53
    s_lshl_b32 s53, s52, 10
    s_add_u32 s54, s53, 104960
    s_mov_b32 m0, s54
    s_cmp_ge_u32 s52, 28
    s_mov_b32 s54, 6422528
    s_cselect_b32 s54, 6426624, s54
    s_add_u32 s53, s53, s54
    buffer_load_dwordx4 v35, s[16:19], s53 offen lds
    s_add_u32 s52, s55, 32
    s_mul_hi_u32 s53, s52, 76695845
    s_mul_i32 s53, s53, 56
    s_sub_u32 s52, s52, s53
    s_min_u32 s52, s52, 53
    s_lshl_b32 s53, s52, 10
    s_add_u32 s54, s53, 104960
    s_mov_b32 m0, s54
    s_cmp_ge_u32 s52, 28
    s_mov_b32 s54, 6422528
    s_cselect_b32 s54, 6426624, s54
    s_add_u32 s53, s53, s54
    buffer_load_dwordx4 v35, s[16:19], s53 offen lds
    s_add_u32 s52, s55, 40
    s_mul_hi_u32 s53, s52, 76695845
    s_mul_i32 s53, s53, 56
    s_sub_u32 s52, s52, s53
    s_min_u32 s52, s52, 53
    s_lshl_b32 s53, s52, 10
    s_add_u32 s54, s53, 104960
    s_mov_b32 m0, s54
    s_cmp_ge_u32 s52, 28
    s_mov_b32 s54, 6422528
    s_cselect_b32 s54, 6426624, s54
    s_add_u32 s53, s53, s54
    buffer_load_dwordx4 v35, s[16:19], s53 offen lds
    s_add_u32 s52, s55, 48
    s_mul_hi_u32 s53, s52, 76695845
    s_mul_i32 s53, s53, 56
    s_sub_u32 s52, s52, s53
    s_min_u32 s52, s52, 53
    s_lshl_b32 s53, s52, 10
    s_add_u32 s54, s53, 104960
    s_mov_b32 m0, s54
    s_cmp_ge_u32 s52, 28
    s_mov_b32 s54, 6422528
    s_cselect_b32 s54, 6426624, s54
    s_add_u32 s53, s53, s54
    buffer_load_dwordx4 v35, s[16:19], s53 offen lds
K2_XD_C:
    s_lshr_b32 s52, s2, 3
    s_lshl_b32 s52, s52, 17
    s_lshl_b32 s53, s43, 14
    s_add_u32 s52, s52, s53
    s_add_u32 s52, s52, 0
    v_lshlrev_b32 v35, 4, v22
    buffer_load_dwordx4 v[184:187], v35, s[12:15], s52 offen offset:0
    buffer_load_dwordx4 v[188:191], v35, s[12:15], s52 offen offset:1024
    s_waitcnt lgkmcnt(0)
    s_barrier
    s_cmp_eq_u32 s48, 1
    s_cbranch_scc1 K2_WREC1
    s_waitcnt vmcnt(0)
    s_branch K2_WREC2
K2_WREC1:
    s_waitcnt vmcnt(9)
K2_WREC2:
    v_mov_b32 v28, 1
    s_cmp_eq_u64 s[56:57], 0
    s_cbranch_scc1 K2_AT_DONE
    s_mov_b64 exec, s[56:57]
    v_lshrrev_b32 v92, 16, v136
    v_subrev_u32 v92, s32, v92
    v_lshlrev_b32 v36, 2, v92
    v_add_u32 v36, 160256, v36
    ds_add_rtn_u32 v102, v36, v28
    s_cmp_eq_u64 s[58:59], 0
    s_cbranch_scc1 K2_AT_DONE
    s_mov_b64 exec, s[58:59]
    v_lshrrev_b32 v93, 16, v137
    v_subrev_u32 v93, s32, v93
    v_lshlrev_b32 v36, 2, v93
    v_add_u32 v36, 160256, v36
    ds_add_rtn_u32 v103, v36, v28
    s_cmp_eq_u64 s[60:61], 0
    s_cbranch_scc1 K2_AT_DONE
    s_mov_b64 exec, s[60:61]
    v_lshrrev_b32 v94, 16, v138
    v_subrev_u32 v94, s32, v94
    v_lshlrev_b32 v36, 2, v94
    v_add_u32 v36, 160256, v36
    ds_add_rtn_u32 v104, v36, v28
    s_cmp_eq_u64 s[62:63], 0
    s_cbranch_scc1 K2_AT_DONE
    s_mov_b64 exec, s[62:63]
    v_lshrrev_b32 v95, 16, v139
    v_subrev_u32 v95, s32, v95
    v_lshlrev_b32 v36, 2, v95
    v_add_u32 v36, 160256, v36
    ds_add_rtn_u32 v105, v36, v28
    s_cmp_eq_u64 s[64:65], 0
    s_cbranch_scc1 K2_AT_DONE
    s_mov_b64 exec, s[64:65]
    v_lshrrev_b32 v96, 16, v140
    v_subrev_u32 v96, s32, v96
    v_lshlrev_b32 v36, 2, v96
    v_add_u32 v36, 160256, v36
    ds_add_rtn_u32 v106, v36, v28
    s_cmp_eq_u64 s[66:67], 0
    s_cbranch_scc1 K2_AT_DONE
    s_mov_b64 exec, s[66:67]
    v_lshrrev_b32 v97, 16, v141
    v_subrev_u32 v97, s32, v97
    v_lshlrev_b32 v36, 2, v97
    v_add_u32 v36, 160256, v36
    ds_add_rtn_u32 v107, v36, v28
    s_cmp_eq_u64 s[68:69], 0
    s_cbranch_scc1 K2_AT_DONE
    s_mov_b64 exec, s[68:69]
    v_lshrrev_b32 v98, 16, v142
    v_subrev_u32 v98, s32, v98
    v_lshlrev_b32 v36, 2, v98
    v_add_u32 v36, 160256, v36
    ds_add_rtn_u32 v108, v36, v28
    s_cmp_eq_u64 s[70:71], 0
    s_cbranch_scc1 K2_AT_DONE
    s_mov_b64 exec, s[70:71]
    v_lshrrev_b32 v99, 16, v143
    v_subrev_u32 v99, s32, v99
    v_lshlrev_b32 v36, 2, v99
    v_add_u32 v36, 160256, v36
    ds_add_rtn_u32 v109, v36, v28
K2_AT_DONE:
    s_mov_b64 exec, s[50:51]
    s_cmp_eq_u32 s48, 1
    s_cbranch_scc0 K2_XD_P4
    v_lshlrev_b32 v35, 4, v22
    s_mul_i32 s52, s2, 9
    s_add_u32 s52, s52, s43
    s_add_u32 s52, s52, 48
    s_mul_hi_u32 s53, s52, 58040099
    s_mul_i32 s53, s53, 74
    s_sub_u32 s52, s52, s53
    s_lshl_b32 s52, s52, 10
    s_add_u32 m0, s52, 12800
    s_add_u32 s53, s52, 8192
    buffer_load_dwordx4 v35, s[80:83], s52 offen lds
    s_sub_u32 s52, s53, 75776
    s_cmp_lt_u32 s53, 75776
    s_cselect_b32 s52, s53, s52
    s_add_u32 m0, s52, 12800
    s_add_u32 s53, s52, 8192
    buffer_load_dwordx4 v35, s[80:83], s52 offen lds
    s_sub_u32 s52, s53, 75776
    s_cmp_lt_u32 s53, 75776
    s_cselect_b32 s52, s53, s52
    s_add_u32 m0, s52, 12800
    s_add_u32 s53, s52, 8192
    buffer_load_dwordx4 v35, s[80:83], s52 offen lds
    s_sub_u32 s52, s53, 75776
    s_cmp_lt_u32 s53, 75776
    s_cselect_b32 s52, s53, s52
    s_add_u32 m0, s52, 12800
    s_nop 0
    buffer_load_dwordx4 v35, s[80:83], s52 offen lds
K2_XD_P4:
    s_lshr_b32 s52, s2, 3
    s_lshl_b32 s52, s52, 17
    s_lshl_b32 s53, s43, 14
    s_add_u32 s52, s52, s53
    s_add_u32 s52, s52, 0
    v_lshlrev_b32 v35, 4, v22
    buffer_load_dwordx4 v[192:195], v35, s[12:15], s52 offen offset:2048
    buffer_load_dwordx4 v[196:199], v35, s[12:15], s52 offen offset:3072
    s_add_u32 s52, s52, 4096
    buffer_load_dwordx4 v[200:203], v35, s[12:15], s52 offen offset:0
    buffer_load_dwordx4 v[204:207], v35, s[12:15], s52 offen offset:1024
    s_waitcnt lgkmcnt(0)
    s_mov_b64 s[88:89], 0
    s_cmp_eq_u64 s[56:57], 0
    s_cbranch_scc1 K2_PL_DONE
    s_mov_b64 exec, s[56:57]
    v_cmp_gt_u32 vcc, 128, v102
    v_lshl_add_u32 v34, v92, 7, v102
    s_andn2_b64 s[52:53], exec, vcc
    s_or_b64 s[88:89], s[88:89], s[52:53]
    s_and_b64 exec, exec, vcc
    v_lshlrev_b32 v34, 1, v34
    ds_write_b16 v34, v136
    s_cmp_eq_u64 s[58:59], 0
    s_cbranch_scc1 K2_PL_DONE
    s_mov_b64 exec, s[58:59]
    v_cmp_gt_u32 vcc, 128, v103
    v_lshl_add_u32 v34, v93, 7, v103
    s_andn2_b64 s[52:53], exec, vcc
    s_or_b64 s[88:89], s[88:89], s[52:53]
    s_and_b64 exec, exec, vcc
    v_lshlrev_b32 v34, 1, v34
    ds_write_b16 v34, v137
    s_cmp_eq_u64 s[60:61], 0
    s_cbranch_scc1 K2_PL_DONE
    s_mov_b64 exec, s[60:61]
    v_cmp_gt_u32 vcc, 128, v104
    v_lshl_add_u32 v34, v94, 7, v104
    s_andn2_b64 s[52:53], exec, vcc
    s_or_b64 s[88:89], s[88:89], s[52:53]
    s_and_b64 exec, exec, vcc
    v_lshlrev_b32 v34, 1, v34
    ds_write_b16 v34, v138
    s_cmp_eq_u64 s[62:63], 0
    s_cbranch_scc1 K2_PL_DONE
    s_mov_b64 exec, s[62:63]
    v_cmp_gt_u32 vcc, 128, v105
    v_lshl_add_u32 v34, v95, 7, v105
    s_andn2_b64 s[52:53], exec, vcc
    s_or_b64 s[88:89], s[88:89], s[52:53]
    s_and_b64 exec, exec, vcc
    v_lshlrev_b32 v34, 1, v34
    ds_write_b16 v34, v139
    s_cmp_eq_u64 s[64:65], 0
    s_cbranch_scc1 K2_PL_DONE
    s_mov_b64 exec, s[64:65]
    v_cmp_gt_u32 vcc, 128, v106
    v_lshl_add_u32 v34, v96, 7, v106
    s_andn2_b64 s[52:53], exec, vcc
    s_or_b64 s[88:89], s[88:89], s[52:53]
    s_and_b64 exec, exec, vcc
    v_lshlrev_b32 v34, 1, v34
    ds_write_b16 v34, v140
    s_cmp_eq_u64 s[66:67], 0
    s_cbranch_scc1 K2_PL_DONE
    s_mov_b64 exec, s[66:67]
    v_cmp_gt_u32 vcc, 128, v107
    v_lshl_add_u32 v34, v97, 7, v107
    s_andn2_b64 s[52:53], exec, vcc
    s_or_b64 s[88:89], s[88:89], s[52:53]
    s_and_b64 exec, exec, vcc
    v_lshlrev_b32 v34, 1, v34
    ds_write_b16 v34, v141
    s_cmp_eq_u64 s[68:69], 0
    s_cbranch_scc1 K2_PL_DONE
    s_mov_b64 exec, s[68:69]
    v_cmp_gt_u32 vcc, 128, v108
    v_lshl_add_u32 v34, v98, 7, v108
    s_andn2_b64 s[52:53], exec, vcc
    s_or_b64 s[88:89], s[88:89], s[52:53]
    s_and_b64 exec, exec, vcc
    v_lshlrev_b32 v34, 1, v34
    ds_write_b16 v34, v142
    s_cmp_eq_u64 s[70:71], 0
    s_cbranch_scc1 K2_PL_DONE
    s_mov_b64 exec, s[70:71]
    v_cmp_gt_u32 vcc, 128, v109
    v_lshl_add_u32 v34, v99, 7, v109
    s_andn2_b64 s[52:53], exec, vcc
    s_or_b64 s[88:89], s[88:89], s[52:53]
    s_and_b64 exec, exec, vcc
    v_lshlrev_b32 v34, 1, v34
    ds_write_b16 v34, v143
K2_PL_DONE:
    s_mov_b64 exec, s[50:51]
    s_lshr_b32 s52, s2, 3
    s_lshl_b32 s52, s52, 17
    s_lshl_b32 s53, s43, 14
    s_add_u32 s52, s52, s53
    s_add_u32 s52, s52, 4096
    v_lshlrev_b32 v35, 4, v22
    buffer_load_dwordx4 v[208:211], v35, s[12:15], s52 offen offset:2048
    buffer_load_dwordx4 v[212:215], v35, s[12:15], s52 offen offset:3072
    s_add_u32 s52, s52, 4096
    v_mov_b32 v35, 160512
    s_cmp_eq_u64 s[88:89], 0
    s_cbranch_scc1 K2_NOOVF
    ds_write_b32 v35, v28 offset:4
K2_NOOVF:
    s_cmp_eq_u32 s76, 0
    s_cbranch_scc1 K2_NOMORE
    ds_write_b32 v35, v28 offset:8
K2_NOMORE:
    s_waitcnt vmcnt(6) lgkmcnt(0)
    s_barrier
    ds_read_b32 v30, v35 offset:4
    ds_read_b32 v31, v35 offset:8
    s_waitcnt lgkmcnt(0)
    v_readfirstlane_b32 s52, v30
    v_readfirstlane_b32 s76, v31
    s_cmp_eq_u32 s52, 0
    s_cbranch_scc1 K2_GO
    s_waitcnt vmcnt(0) lgkmcnt(0)
    s_lshr_b32 s45, s45, 1
    s_branch K2_ROUND
K2_GO:
    s_xor_b32 s49, s76, 1
    v_mov_b32 v13, 160512
    v_mov_b32 v14, 1
    s_mov_b64 exec, 1
    ds_add_rtn_u32 v250, v13, v14
    ds_add_rtn_u32 v251, v13, v14
    s_mov_b64 exec, s[50:51]
    s_waitcnt lgkmcnt(0)
    v_readfirstlane_b32 s34, v250
    v_readfirstlane_b32 s36, v251
    s_cmp_ge_u32 s34, s33
    s_cbranch_scc1 K2_WAVE_DONE
    s_lshl_b32 s52, s34, 2
    s_add_u32 s52, s52, 160256
    v_mov_b32 v15, s52
    ds_read_b32 v250, v15
    s_lshl_b32 s39, s34, 7
    s_lshl_b32 s52, s39, 1
    v_add_u32 v6, s52, v4
    ds_read_b128 v[16:19], v6
    v_mov_b32 v8, 0
    v_mov_b32 v9, 0
    v_mov_b32 v10, 0
    v_mov_b32 v11, 0
    s_waitcnt lgkmcnt(0)
    v_readfirstlane_b32 s77, v250
    v_mad_u32_u16 v40, v16, s31, v1 op_sel:[0,0,0,0]
    v_mad_u32_u16 v41, v16, s31, v1 op_sel:[1,0,0,0]
    v_mad_u32_u16 v42, v17, s31, v1 op_sel:[0,0,0,0]
    v_mad_u32_u16 v43, v17, s31, v1 op_sel:[1,0,0,0]
    v_mad_u32_u16 v44, v18, s31, v1 op_sel:[0,0,0,0]
    v_mad_u32_u16 v45, v18, s31, v1 op_sel:[1,0,0,0]
    v_mad_u32_u16 v46, v19, s31, v1 op_sel:[0,0,0,0]
    v_mad_u32_u16 v47, v19, s31, v1 op_sel:[1,0,0,0]
    buffer_load_dwordx4 v[72:75], v40, s[12:15], 0 offen
    buffer_load_dwordx4 v[76:79], v41, s[12:15], 0 offen
    buffer_load_dwordx4 v[80:83], v42, s[12:15], 0 offen
    buffer_load_dwordx4 v[84:87], v43, s[12:15], 0 offen
    buffer_load_dwordx4 v[88:91], v44, s[12:15], 0 offen
    buffer_load_dwordx4 v[92:95], v45, s[12:15], 0 offen
    buffer_load_dwordx4 v[96:99], v46, s[12:15], 0 offen
    buffer_load_dwordx4 v[100:103], v47, s[12:15], 0 offen
    buffer_load_dwordx4 v[104:107], v40, s[12:15], 0 offen offset:256
    buffer_load_dwordx4 v[108:111], v41, s[12:15], 0 offen offset:256
    buffer_load_dwordx4 v[112:115], v42, s[12:15], 0 offen offset:256
    buffer_load_dwordx4 v[116:119], v43, s[12:15], 0 offen offset:256
    buffer_load_dwordx4 v[120:123], v44, s[12:15], 0 offen offset:256
    buffer_load_dwordx4 v[124:127], v45, s[12:15], 0 offen offset:256
    buffer_load_dwordx4 v[128:131], v46, s[12:15], 0 offen offset:256
    buffer_load_dwordx4 v[132:135], v47, s[12:15], 0 offen offset:256
    s_add_u32 s52, s32, s34
    s_lshl_b32 s52, s52, 9
    buffer_load_short_d16_hi v8, v7, s[20:23], s52 offen offset:0 nt
    buffer_load_short_d16_hi v9, v7, s[20:23], s52 offen offset:128 nt
    buffer_load_short_d16_hi v10, v7, s[20:23], s52 offen offset:256 nt
    buffer_load_short_d16_hi v11, v7, s[20:23], s52 offen offset:384 nt
    s_add_u32 s35, s77, 31
    s_lshr_b32 s35, s35, 5
    s_max_u32 s35, s35, 1
    s_lshl_b32 s52, s34, 8
    v_lshlrev_b32 v37, 1, v22
    v_add_u32 v37, s52, v37
    ds_read_u16 v24, v37
    ds_read_u16 v25, v37 offset:128
    s_add_u32 s52, s32, s34
    s_mul_i32 s52, s52, 6
    s_add_u32 s52, s52, 12800
    s_min_u32 s52, s52, 87794
    v_mov_b32 v38, s52
    v_mov_b32 v30, 0
    v_mov_b32 v31, 0
    v_mov_b32 v32, 0
    ds_read_u16_d16_hi v30, v38 offset:0
    ds_read_u16_d16_hi v31, v38 offset:2
    ds_read_u16_d16_hi v32, v38 offset:4
    s_mov_b32 s84, 0
    v_mov_b32 v34, 133632
    v_mov_b32 v36, 0
    s_waitcnt lgkmcnt(3)
    s_sub_i32 s53, s77, 0
    v_cmp_gt_i32 s[56:57], s53, v22
    s_nop 1
    v_cndmask_b32 v24, 0, v24, s[56:57]
    v_mul_u32_u24 v37, 6, v24
    v_and_b32 v37, -4, v37
    v_add_u32 v37, 12800, v37
    ds_read2_b32 v[26:27], v37 offset0:0 offset1:1
    v_and_b32 v24, 1, v24
    v_lshlrev_b32 v24, 4, v24
    s_sub_i32 s53, s77, 64
    v_cmp_gt_i32 s[58:59], s53, v22
    s_nop 1
    v_cndmask_b32 v25, 0, v25, s[58:59]
    v_mul_u32_u24 v37, 6, v25
    v_and_b32 v37, -4, v37
    v_add_u32 v37, 12800, v37
    ds_read2_b32 v[28:29], v37 offset0:0 offset1:1
    v_and_b32 v25, 1, v25
    v_lshlrev_b32 v25, 4, v25
    s_waitcnt lgkmcnt(1)
    v_alignbit_b32 v40, v27, v26, v24
    v_lshrrev_b32 v41, v24, v27
    v_lshlrev_b32 v39, 16, v40
    v_and_b32 v40, s28, v40
    v_lshlrev_b32 v41, 16, v41
    v_sub_f32 v39, v39, v30
    v_sub_f32 v40, v40, v31
    v_sub_f32 v41, v41, v32
    v_cvt_pk_bf16_f32 v42, v39, v40
    v_lshlrev_b32 v39, 16, v42
    v_and_b32 v40, s28, v42
    v_cvt_pk_bf16_f32 v41, v41, v41
    v_and_b32 v41, s28, v41
    v_mul_f32 v43, v39, v39
    v_mul_f32 v44, v40, v40
    v_mul_f32 v45, v41, v41
    v_cvt_pk_bf16_f32 v42, v43, v44
    v_lshlrev_b32 v43, 16, v42
    v_and_b32 v44, s28, v42
    v_cvt_pk_bf16_f32 v45, v45, v45
    v_and_b32 v45, s28, v45
    v_add_f32 v46, v43, v44
    v_add_f32 v46, v46, v45
    v_cvt_pk_bf16_f32 v46, v46, v46
    v_and_b32 v46, s28, v46
    v_add_f32 v46, 0x322bcc77, v46
    v_cvt_pk_bf16_f32 v46, v46, v46
    v_and_b32 v46, s28, v46
    v_sqrt_f32 v46, v46
    s_nop 0
    v_cvt_pk_bf16_f32 v46, v46, v46
    v_and_b32 v46, s28, v46
    v_rcp_f32 v43, v46
    v_cmp_gt_f32 vcc, 0x40a00000, v46
    s_nop 0
    s_and_b64 s[54:55], vcc, s[56:57]
    v_lshrrev_b32 v44, 16, v46
    v_mul_f32 v39, v39, v43
    v_mul_f32 v40, v40, v43
    v_mul_f32 v41, v41, v43
    v_cmp_gt_u32 vcc, 15744, v44
    v_lshlrev_b32 v44, 5, v44
    v_add_u32 v44, -370144, v44
    s_and_b64 vcc, vcc, s[54:55]
    s_cmp_lg_u64 vcc, 0
    s_cselect_b32 s52, 1, 0
    s_or_b32 s84, s84, s52
    v_cvt_pk_bf16_f32 v42, v39, v40
    v_lshlrev_b32 v39, 16, v42
    v_and_b32 v40, s28, v42
    v_cvt_pk_bf16_f32 v41, v41, v41
    v_and_b32 v41, s28, v41
    v_mov_b32 v45, 133632
    v_cndmask_b32 v33, v45, v44, s[54:55]
    v_cndmask_b32 v35, 0, v46, s[54:55]
    v_lshl_add_u32 v37, v22, 2, v23
    ds_write_b32 v37, v39 offset:512
    ds_write_b32 v37, v40 offset:1024
    ds_write_b32 v37, v41 offset:1536
    s_cmp_le_u32 s77, 64
    s_cbranch_scc1 K2_GEO_W_P
    s_waitcnt lgkmcnt(0)
    v_alignbit_b32 v40, v29, v28, v25
    v_lshrrev_b32 v41, v25, v29
    v_lshlrev_b32 v39, 16, v40
    v_and_b32 v40, s28, v40
    v_lshlrev_b32 v41, 16, v41
    v_sub_f32 v39, v39, v30
    v_sub_f32 v40, v40, v31
    v_sub_f32 v41, v41, v32
    v_cvt_pk_bf16_f32 v42, v39, v40
    v_lshlrev_b32 v39, 16, v42
    v_and_b32 v40, s28, v42
    v_cvt_pk_bf16_f32 v41, v41, v41
    v_and_b32 v41, s28, v41
    v_mul_f32 v43, v39, v39
    v_mul_f32 v44, v40, v40
    v_mul_f32 v45, v41, v41
    v_cvt_pk_bf16_f32 v42, v43, v44
    v_lshlrev_b32 v43, 16, v42
    v_and_b32 v44, s28, v42
    v_cvt_pk_bf16_f32 v45, v45, v45
    v_and_b32 v45, s28, v45
    v_add_f32 v46, v43, v44
    v_add_f32 v46, v46, v45
    v_cvt_pk_bf16_f32 v46, v46, v46
    v_and_b32 v46, s28, v46
    v_add_f32 v46, 0x322bcc77, v46
    v_cvt_pk_bf16_f32 v46, v46, v46
    v_and_b32 v46, s28, v46
    v_sqrt_f32 v46, v46
    s_nop 0
    v_cvt_pk_bf16_f32 v46, v46, v46
    v_and_b32 v46, s28, v46
    v_rcp_f32 v43, v46
    v_cmp_gt_f32 vcc, 0x40a00000, v46
    s_nop 0
    s_and_b64 s[54:55], vcc, s[58:59]
    v_lshrrev_b32 v44, 16, v46
    v_mul_f32 v39, v39, v43
    v_mul_f32 v40, v40, v43
    v_mul_f32 v41, v41, v43
    v_cmp_gt_u32 vcc, 15744, v44
    v_lshlrev_b32 v44, 5, v44
    v_add_u32 v44, -370144, v44
    s_and_b64 vcc, vcc, s[54:55]
    s_cmp_lg_u64 vcc, 0
    s_cselect_b32 s52, 1, 0
    s_or_b32 s84, s84, s52
    v_cvt_pk_bf16_f32 v42, v39, v40
    v_lshlrev_b32 v39, 16, v42
    v_and_b32 v40, s28, v42
    v_cvt_pk_bf16_f32 v41, v41, v41
    v_and_b32 v41, s28, v41
    v_mov_b32 v45, 133632
    v_cndmask_b32 v34, v45, v44, s[54:55]
    v_cndmask_b32 v36, 0, v46, s[54:55]
    v_lshl_add_u32 v37, v22, 2, v23
    ds_write_b32 v37, v39 offset:768
    ds_write_b32 v37, v40 offset:1280
    ds_write_b32 v37, v41 offset:1792
K2_GEO_W_P:
    v_lshl_add_u32 v37, v22, 2, v23
    s_cmp_eq_u32 s84, 1
    s_cbranch_scc1 K2_GEO_S_P
    ds_write_b32 v37, v33
    ds_write_b32 v37, v34 offset:256
    s_branch K2_GEO_END_P
K2_GEO_S_P:
    ds_write_b32 v37, v35
    ds_write_b32 v37, v36 offset:256
K2_GEO_END_P:
    v_mov_b32 v5, v3
    v_mov_b32 v21, v20
K2_NODE:
    s_mov_b32 s38, 0
    v_mov_b32 v13, 160512
    v_mov_b32 v14, 1
    s_min_u32 s52, s36, 49
    s_lshl_b32 s52, s52, 2
    s_add_u32 s52, s52, 160256
    v_mov_b32 v15, s52
    s_mov_b64 s[50:51], exec
    s_mov_b64 exec, 1
    ds_add_rtn_u32 v250, v13, v14
    ds_read_b32 v251, v15
    s_mov_b64 exec, s[50:51]
    s_add_u32 s52, s38, 1
    s_cmp_eq_u32 s52, s35
    s_cselect_b32 s42, 1, 0
    s_min_u32 s53, s36, 49
    s_lshl_b32 s53, s53, 7
    s_add_u32 s54, s39, 32
    s_cmp_eq_u32 s42, 1
    s_cselect_b32 s40, s53, s54
    s_lshl_b32 s52, s40, 1
    v_add_u32 v6, s52, v4
    s_cmp_eq_u32 s84, 1
    s_cbranch_scc1 K2_SLOWG_F
    ds_read2_b32 v[48:49], v5 offset0:0 offset1:4
    ds_read_b128 v[24:27], v21 offset:512
    ds_read_b128 v[28:31], v21 offset:528
    ds_read_b128 v[32:35], v21 offset:1024
    ds_read_b128 v[36:39], v21 offset:1040
    ds_read_b128 v[40:43], v21 offset:1536
    ds_read_b128 v[44:47], v21 offset:1552
    s_waitcnt lgkmcnt(6)
    v_add_u32 v48, v48, v254
    v_add_u32 v49, v49, v254
    ds_read_b64_tr_b16 v[56:57], v48
    ds_read_b64_tr_b16 v[58:59], v49
    ds_read_b128 v[16:19], v6
    s_waitcnt lgkmcnt(1)
    s_branch K2_G1_F
K2_SLOWG_F:
    ds_read_b128 v[24:27], v21
    ds_read_b128 v[28:31], v21 offset:16
    s_waitcnt lgkmcnt(0)
    v_rcp_f32 v52, v24
    v_mul_f32 v50, 0x40490fdb, v24
    v_cvt_pk_bf16_f32 v50, v50, v50
    v_and_b32 v50, s28, v50
    v_mul_f32 v50, 0x3e4ccccd, v50
    v_cvt_pk_bf16_f32 v50, v50, v50
    v_and_b32 v50, s28, v50
    v_mul_f32 v50, 0.15915494, v50
    v_cos_f32 v50, v50
    s_nop 0
    v_cvt_pk_bf16_f32 v50, v50, v50
    v_and_b32 v50, s28, v50
    v_add_f32 v50, 1.0, v50
    v_cvt_pk_bf16_f32 v50, v50, v50
    v_and_b32 v50, s28, v50
    v_mul_f32 v52, 0.5, v52
    v_mul_f32 v50, v50, v52
    v_cmp_lt_f32 vcc, 0, v24
    v_mul_f32 v54, v24, v2
    v_cvt_pk_bf16_f32 v54, v54, v54
    v_and_b32 v54, s28, v54
    v_cndmask_b32 v50, 0, v50, vcc
    v_mul_f32 v54, 0.15915494, v54
    v_sin_f32 v54, v54
    s_nop 0
    v_mul_f32 v54, v54, v50
    v_rcp_f32 v53, v25
    v_mul_f32 v51, 0x40490fdb, v25
    v_cvt_pk_bf16_f32 v51, v51, v51
    v_and_b32 v51, s28, v51
    v_mul_f32 v51, 0x3e4ccccd, v51
    v_cvt_pk_bf16_f32 v51, v51, v51
    v_and_b32 v51, s28, v51
    v_mul_f32 v51, 0.15915494, v51
    v_cos_f32 v51, v51
    s_nop 0
    v_cvt_pk_bf16_f32 v51, v51, v51
    v_and_b32 v51, s28, v51
    v_add_f32 v51, 1.0, v51
    v_cvt_pk_bf16_f32 v51, v51, v51
    v_and_b32 v51, s28, v51
    v_mul_f32 v53, 0.5, v53
    v_mul_f32 v51, v51, v53
    v_cmp_lt_f32 vcc, 0, v25
    v_mul_f32 v55, v25, v2
    v_cvt_pk_bf16_f32 v55, v55, v55
    v_and_b32 v55, s28, v55
    v_cndmask_b32 v51, 0, v51, vcc
    v_mul_f32 v55, 0.15915494, v55
    v_sin_f32 v55, v55
    s_nop 0
    v_mul_f32 v55, v55, v51
    v_cvt_pk_bf16_f32 v56, v54, v55
    v_rcp_f32 v52, v26
    v_mul_f32 v50, 0x40490fdb, v26
    v_cvt_pk_bf16_f32 v50, v50, v50
    v_and_b32 v50, s28, v50
    v_mul_f32 v50, 0x3e4ccccd, v50
    v_cvt_pk_bf16_f32 v50, v50, v50
    v_and_b32 v50, s28, v50
    v_mul_f32 v50, 0.15915494, v50
    v_cos_f32 v50, v50
    s_nop 0
    v_cvt_pk_bf16_f32 v50, v50, v50
    v_and_b32 v50, s28, v50
    v_add_f32 v50, 1.0, v50
    v_cvt_pk_bf16_f32 v50, v50, v50
    v_and_b32 v50, s28, v50
    v_mul_f32 v52, 0.5, v52
    v_mul_f32 v50, v50, v52
    v_cmp_lt_f32 vcc, 0, v26
    v_mul_f32 v54, v26, v2
    v_cvt_pk_bf16_f32 v54, v54, v54
    v_and_b32 v54, s28, v54
    v_cndmask_b32 v50, 0, v50, vcc
    v_mul_f32 v54, 0.15915494, v54
    v_sin_f32 v54, v54
    s_nop 0
    v_mul_f32 v54, v54, v50
    v_rcp_f32 v53, v27
    v_mul_f32 v51, 0x40490fdb, v27
    v_cvt_pk_bf16_f32 v51, v51, v51
    v_and_b32 v51, s28, v51
    v_mul_f32 v51, 0x3e4ccccd, v51
    v_cvt_pk_bf16_f32 v51, v51, v51
    v_and_b32 v51, s28, v51
    v_mul_f32 v51, 0.15915494, v51
    v_cos_f32 v51, v51
    s_nop 0
    v_cvt_pk_bf16_f32 v51, v51, v51
    v_and_b32 v51, s28, v51
    v_add_f32 v51, 1.0, v51
    v_cvt_pk_bf16_f32 v51, v51, v51
    v_and_b32 v51, s28, v51
    v_mul_f32 v53, 0.5, v53
    v_mul_f32 v51, v51, v53
    v_cmp_lt_f32 vcc, 0, v27
    v_mul_f32 v55, v27, v2
    v_cvt_pk_bf16_f32 v55, v55, v55
    v_and_b32 v55, s28, v55
    v_cndmask_b32 v51, 0, v51, vcc
    v_mul_f32 v55, 0.15915494, v55
    v_sin_f32 v55, v55
    s_nop 0
    v_mul_f32 v55, v55, v51
    v_cvt_pk_bf16_f32 v57, v54, v55
    v_rcp_f32 v52, v28
    v_mul_f32 v50, 0x40490fdb, v28
    v_cvt_pk_bf16_f32 v50, v50, v50
    v_and_b32 v50, s28, v50
    v_mul_f32 v50, 0x3e4ccccd, v50
    v_cvt_pk_bf16_f32 v50, v50, v50
    v_and_b32 v50, s28, v50
    v_mul_f32 v50, 0.15915494, v50
    v_cos_f32 v50, v50
    s_nop 0
    v_cvt_pk_bf16_f32 v50, v50, v50
    v_and_b32 v50, s28, v50
    v_add_f32 v50, 1.0, v50
    v_cvt_pk_bf16_f32 v50, v50, v50
    v_and_b32 v50, s28, v50
    v_mul_f32 v52, 0.5, v52
    v_mul_f32 v50, v50, v52
    v_cmp_lt_f32 vcc, 0, v28
    v_mul_f32 v54, v28, v2
    v_cvt_pk_bf16_f32 v54, v54, v54
    v_and_b32 v54, s28, v54
    v_cndmask_b32 v50, 0, v50, vcc
    v_mul_f32 v54, 0.15915494, v54
    v_sin_f32 v54, v54
    s_nop 0
    v_mul_f32 v54, v54, v50
    v_rcp_f32 v53, v29
    v_mul_f32 v51, 0x40490fdb, v29
    v_cvt_pk_bf16_f32 v51, v51, v51
    v_and_b32 v51, s28, v51
    v_mul_f32 v51, 0x3e4ccccd, v51
    v_cvt_pk_bf16_f32 v51, v51, v51
    v_and_b32 v51, s28, v51
    v_mul_f32 v51, 0.15915494, v51
    v_cos_f32 v51, v51
    s_nop 0
    v_cvt_pk_bf16_f32 v51, v51, v51
    v_and_b32 v51, s28, v51
    v_add_f32 v51, 1.0, v51
    v_cvt_pk_bf16_f32 v51, v51, v51
    v_and_b32 v51, s28, v51
    v_mul_f32 v53, 0.5, v53
    v_mul_f32 v51, v51, v53
    v_cmp_lt_f32 vcc, 0, v29
    v_mul_f32 v55, v29, v2
    v_cvt_pk_bf16_f32 v55, v55, v55
    v_and_b32 v55, s28, v55
    v_cndmask_b32 v51, 0, v51, vcc
    v_mul_f32 v55, 0.15915494, v55
    v_sin_f32 v55, v55
    s_nop 0
    v_mul_f32 v55, v55, v51
    v_cvt_pk_bf16_f32 v58, v54, v55
    v_rcp_f32 v52, v30
    v_mul_f32 v50, 0x40490fdb, v30
    v_cvt_pk_bf16_f32 v50, v50, v50
    v_and_b32 v50, s28, v50
    v_mul_f32 v50, 0x3e4ccccd, v50
    v_cvt_pk_bf16_f32 v50, v50, v50
    v_and_b32 v50, s28, v50
    v_mul_f32 v50, 0.15915494, v50
    v_cos_f32 v50, v50
    s_nop 0
    v_cvt_pk_bf16_f32 v50, v50, v50
    v_and_b32 v50, s28, v50
    v_add_f32 v50, 1.0, v50
    v_cvt_pk_bf16_f32 v50, v50, v50
    v_and_b32 v50, s28, v50
    v_mul_f32 v52, 0.5, v52
    v_mul_f32 v50, v50, v52
    v_cmp_lt_f32 vcc, 0, v30
    v_mul_f32 v54, v30, v2
    v_cvt_pk_bf16_f32 v54, v54, v54
    v_and_b32 v54, s28, v54
    v_cndmask_b32 v50, 0, v50, vcc
    v_mul_f32 v54, 0.15915494, v54
    v_sin_f32 v54, v54
    s_nop 0
    v_mul_f32 v54, v54, v50
    v_rcp_f32 v53, v31
    v_mul_f32 v51, 0x40490fdb, v31
    v_cvt_pk_bf16_f32 v51, v51, v51
    v_and_b32 v51, s28, v51
    v_mul_f32 v51, 0x3e4ccccd, v51
    v_cvt_pk_bf16_f32 v51, v51, v51
    v_and_b32 v51, s28, v51
    v_mul_f32 v51, 0.15915494, v51
    v_cos_f32 v51, v51
    s_nop 0
    v_cvt_pk_bf16_f32 v51, v51, v51
    v_and_b32 v51, s28, v51
    v_add_f32 v51, 1.0, v51
    v_cvt_pk_bf16_f32 v51, v51, v51
    v_and_b32 v51, s28, v51
    v_mul_f32 v53, 0.5, v53
    v_mul_f32 v51, v51, v53
    v_cmp_lt_f32 vcc, 0, v31
    v_mul_f32 v55, v31, v2
    v_cvt_pk_bf16_f32 v55, v55, v55
    v_and_b32 v55, s28, v55
    v_cndmask_b32 v51, 0, v51, vcc
    v_mul_f32 v55, 0.15915494, v55
    v_sin_f32 v55, v55
    s_nop 0
    v_mul_f32 v55, v55, v51
    v_cvt_pk_bf16_f32 v59, v54, v55
    ds_read_b128 v[24:27], v21 offset:512
    ds_read_b128 v[28:31], v21 offset:528
    ds_read_b128 v[32:35], v21 offset:1024
    ds_read_b128 v[36:39], v21 offset:1040
    ds_read_b128 v[40:43], v21 offset:1536
    ds_read_b128 v[44:47], v21 offset:1552
    ds_read_b128 v[16:19], v6
    s_waitcnt lgkmcnt(1)
K2_G1_F:
    v_lshlrev_b32 v50, 16, v56
    v_and_b32 v51, s28, v56
    v_pk_mul_f32 v[52:53], v[50:51], v[24:25]
    v_cvt_pk_bf16_f32 v60, v52, v53
    v_pk_mul_f32 v[54:55], v[50:51], v[32:33]
    v_cvt_pk_bf16_f32 v64, v54, v55
    v_pk_mul_f32 v[52:53], v[50:51], v[40:41]
    v_cvt_pk_bf16_f32 v68, v52, v53
    v_lshlrev_b32 v50, 16, v57
    v_and_b32 v51, s28, v57
    v_pk_mul_f32 v[52:53], v[50:51], v[26:27]
    v_cvt_pk_bf16_f32 v61, v52, v53
    v_pk_mul_f32 v[54:55], v[50:51], v[34:35]
    v_cvt_pk_bf16_f32 v65, v54, v55
    v_pk_mul_f32 v[52:53], v[50:51], v[42:43]
    v_cvt_pk_bf16_f32 v69, v52, v53
    v_lshlrev_b32 v50, 16, v58
    v_and_b32 v51, s28, v58
    v_pk_mul_f32 v[52:53], v[50:51], v[28:29]
    v_cvt_pk_bf16_f32 v62, v52, v53
    v_pk_mul_f32 v[54:55], v[50:51], v[36:37]
    v_cvt_pk_bf16_f32 v66, v54, v55
    v_pk_mul_f32 v[52:53], v[50:51], v[44:45]
    v_cvt_pk_bf16_f32 v70, v52, v53
    v_lshlrev_b32 v50, 16, v59
    v_and_b32 v51, s28, v59
    v_pk_mul_f32 v[52:53], v[50:51], v[30:31]
    v_cvt_pk_bf16_f32 v63, v52, v53
    v_pk_mul_f32 v[54:55], v[50:51], v[38:39]
    v_cvt_pk_bf16_f32 v67, v54, v55
    v_pk_mul_f32 v[52:53], v[50:51], v[46:47]
    v_cvt_pk_bf16_f32 v71, v52, v53
    v_readfirstlane_b32 s41, v250
    v_readfirstlane_b32 s77, v251
    s_nop 0
    s_add_u32 s37, s77, 31
    s_lshr_b32 s37, s37, 5
    s_max_u32 s37, s37, 1
    s_waitcnt vmcnt(8)
    v_perm_b32 v24, v76, v72, s29
    v_perm_b32 v25, v84, v80, s29
    v_perm_b32 v26, v92, v88, s29
    v_perm_b32 v27, v100, v96, s29
    v_perm_b32 v28, v76, v72, s30
    v_perm_b32 v29, v84, v80, s30
    v_perm_b32 v30, v92, v88, s30
    v_perm_b32 v31, v100, v96, s30
    v_mfma_f32_16x16x32_bf16 v[136:139], v[56:59], v[24:27], 0
    v_perm_b32 v32, v77, v73, s29
    v_perm_b32 v33, v85, v81, s29
    v_perm_b32 v34, v93, v89, s29
    v_perm_b32 v35, v101, v97, s29
    v_mfma_f32_16x16x32_bf16 v[140:143], v[56:59], v[28:31], 0
    v_perm_b32 v36, v77, v73, s30
    v_perm_b32 v37, v85, v81, s30
    v_perm_b32 v38, v93, v89, s30
    v_perm_b32 v39, v101, v97, s30
    v_mfma_f32_16x16x32_bf16 v[144:147], v[56:59], v[32:35], 0
    v_perm_b32 v24, v78, v74, s29
    v_perm_b32 v25, v86, v82, s29
    v_perm_b32 v26, v94, v90, s29
    v_perm_b32 v27, v102, v98, s29
    v_mfma_f32_16x16x32_bf16 v[148:151], v[56:59], v[36:39], 0
    v_perm_b32 v28, v78, v74, s30
    v_perm_b32 v29, v86, v82, s30
    v_perm_b32 v30, v94, v90, s30
    v_perm_b32 v31, v102, v98, s30
    v_mfma_f32_16x16x32_bf16 v[152:155], v[56:59], v[24:27], 0
    v_perm_b32 v32, v79, v75, s29
    v_perm_b32 v33, v87, v83, s29
    v_perm_b32 v34, v95, v91, s29
    v_perm_b32 v35, v103, v99, s29
    v_mfma_f32_16x16x32_bf16 v[156:159], v[56:59], v[28:31], 0
    v_perm_b32 v36, v79, v75, s30
    v_perm_b32 v37, v87, v83, s30
    v_perm_b32 v38, v95, v91, s30
    v_perm_b32 v39, v103, v99, s30
    v_mfma_f32_16x16x32_bf16 v[160:163], v[56:59], v[32:35], 0
    s_waitcnt lgkmcnt(0)
    v_mad_u32_u16 v40, v16, s31, v1 op_sel:[0,0,0,0]
    v_mad_u32_u16 v41, v16, s31, v1 op_sel:[1,0,0,0]
    v_mfma_f32_16x16x32_bf16 v[164:167], v[56:59], v[36:39], 0
    v_mad_u32_u16 v42, v17, s31, v1 op_sel:[0,0,0,0]
    v_mad_u32_u16 v43, v17, s31, v1 op_sel:[1,0,0,0]
    v_mad_u32_u16 v44, v18, s31, v1 op_sel:[0,0,0,0]
    v_mad_u32_u16 v45, v18, s31, v1 op_sel:[1,0,0,0]
    v_mad_u32_u16 v46, v19, s31, v1 op_sel:[0,0,0,0]
    v_mad_u32_u16 v47, v19, s31, v1 op_sel:[1,0,0,0]
    buffer_load_dwordx4 v[72:75], v40, s[12:15], 0 offen
    buffer_load_dwordx4 v[76:79], v41, s[12:15], 0 offen
    buffer_load_dwordx4 v[80:83], v42, s[12:15], 0 offen
    buffer_load_dwordx4 v[84:87], v43, s[12:15], 0 offen
    buffer_load_dwordx4 v[88:91], v44, s[12:15], 0 offen
    buffer_load_dwordx4 v[92:95], v45, s[12:15], 0 offen
    buffer_load_dwordx4 v[96:99], v46, s[12:15], 0 offen
    buffer_load_dwordx4 v[100:103], v47, s[12:15], 0 offen
    s_waitcnt vmcnt(8)
    v_perm_b32 v24, v110, v106, s29
    v_perm_b32 v25, v118, v114, s29
    v_perm_b32 v26, v126, v122, s29
    v_perm_b32 v27, v134, v130, s29
    v_perm_b32 v28, v110, v106, s30
    v_perm_b32 v29, v118, v114, s30
    v_mfma_f32_16x16x32_bf16 v[184:187], v[24:27], v[56:59], 0
    v_perm_b32 v30, v126, v122, s30
    v_mfma_f32_16x16x32_bf16 v[200:203], v[24:27], v[60:63], 0
    v_perm_b32 v31, v134, v130, s30
    v_mfma_f32_16x16x32_bf16 v[216:219], v[24:27], v[64:67], 0
    v_mfma_f32_16x16x32_bf16 v[232:235], v[24:27], v[68:71], 0
    v_perm_b32 v32, v111, v107, s29
    v_perm_b32 v33, v119, v115, s29
    v_mfma_f32_16x16x32_bf16 v[188:191], v[28:31], v[56:59], 0
    v_perm_b32 v34, v127, v123, s29
    v_mfma_f32_16x16x32_bf16 v[204:207], v[28:31], v[60:63], 0
    v_perm_b32 v35, v135, v131, s29
    v_mfma_f32_16x16x32_bf16 v[220:223], v[28:31], v[64:67], 0
    v_mfma_f32_16x16x32_bf16 v[236:239], v[28:31], v[68:71], 0
    v_perm_b32 v36, v111, v107, s30
    v_perm_b32 v37, v119, v115, s30
    v_mfma_f32_16x16x32_bf16 v[192:195], v[32:35], v[56:59], 0
    v_perm_b32 v38, v127, v123, s30
    v_mfma_f32_16x16x32_bf16 v[208:211], v[32:35], v[60:63], 0
    v_perm_b32 v39, v135, v131, s30
    v_mfma_f32_16x16x32_bf16 v[224:227], v[32:35], v[64:67], 0
    v_mfma_f32_16x16x32_bf16 v[240:243], v[32:35], v[68:71], 0
    v_perm_b32 v24, v108, v104, s29
    v_perm_b32 v25, v116, v112, s29
    v_mfma_f32_16x16x32_bf16 v[196:199], v[36:39], v[56:59], 0
    v_perm_b32 v26, v124, v120, s29
    v_mfma_f32_16x16x32_bf16 v[212:215], v[36:39], v[60:63], 0
    v_perm_b32 v27, v132, v128, s29
    v_mfma_f32_16x16x32_bf16 v[228:231], v[36:39], v[64:67], 0
    v_mfma_f32_16x16x32_bf16 v[244:247], v[36:39], v[68:71], 0
    v_perm_b32 v28, v108, v104, s30
    v_perm_b32 v29, v116, v112, s30
    v_perm_b32 v30, v124, v120, s30
    v_perm_b32 v31, v132, v128, s30
    v_mfma_f32_16x16x32_bf16 v[168:171], v[56:59], v[24:27], 0
    v_perm_b32 v32, v109, v105, s29
    v_perm_b32 v33, v117, v113, s29
    v_perm_b32 v34, v125, v121, s29
    v_perm_b32 v35, v133, v129, s29
    v_mfma_f32_16x16x32_bf16 v[172:175], v[56:59], v[28:31], 0
    v_perm_b32 v36, v109, v105, s30
    v_perm_b32 v37, v117, v113, s30
    v_perm_b32 v38, v125, v121, s30
    v_perm_b32 v39, v133, v129, s30
    v_mfma_f32_16x16x32_bf16 v[176:179], v[56:59], v[32:35], 0
    buffer_load_dwordx4 v[104:107], v40, s[12:15], 0 offen offset:256
    buffer_load_dwordx4 v[108:111], v41, s[12:15], 0 offen offset:256
    v_mfma_f32_16x16x32_bf16 v[180:183], v[56:59], v[36:39], 0
    buffer_load_dwordx4 v[112:115], v42, s[12:15], 0 offen offset:256
    buffer_load_dwordx4 v[116:119], v43, s[12:15], 0 offen offset:256
    buffer_load_dwordx4 v[120:123], v44, s[12:15], 0 offen offset:256
    buffer_load_dwordx4 v[124:127], v45, s[12:15], 0 offen offset:256
    buffer_load_dwordx4 v[128:131], v46, s[12:15], 0 offen offset:256
    buffer_load_dwordx4 v[132:135], v47, s[12:15], 0 offen offset:256
    s_mov_b32 s39, s40
    v_add_u32 v5, 128, v5
    v_add_u32 v21, 128, v21
    s_cmp_eq_u32 s42, 1
    s_cbranch_scc1 K2_EPI
K2_STEP:
    s_add_u32 s38, s38, 1
    s_add_u32 s52, s38, 1
    s_cmp_eq_u32 s52, s35
    s_cselect_b32 s42, 1, 0
    s_min_u32 s53, s36, 49
    s_lshl_b32 s53, s53, 7
    s_add_u32 s54, s39, 32
    s_cmp_eq_u32 s42, 1
    s_cselect_b32 s40, s53, s54
    s_lshl_b32 s52, s40, 1
    v_add_u32 v6, s52, v4
    s_cmp_eq_u32 s84, 1
    s_cbranch_scc1 K2_SLOWG_R
    ds_read2_b32 v[48:49], v5 offset0:0 offset1:4
    ds_read_b128 v[24:27], v21 offset:512
    ds_read_b128 v[28:31], v21 offset:528
    ds_read_b128 v[32:35], v21 offset:1024
    ds_read_b128 v[36:39], v21 offset:1040
    ds_read_b128 v[40:43], v21 offset:1536
    ds_read_b128 v[44:47], v21 offset:1552
    s_waitcnt lgkmcnt(6)
    v_add_u32 v48, v48, v254
    v_add_u32 v49, v49, v254
    ds_read_b64_tr_b16 v[56:57], v48
    ds_read_b64_tr_b16 v[58:59], v49
    ds_read_b128 v[16:19], v6
    s_waitcnt lgkmcnt(1)
    s_branch K2_G1_R
K2_SLOWG_R:
    ds_read_b128 v[24:27], v21
    ds_read_b128 v[28:31], v21 offset:16
    s_waitcnt lgkmcnt(0)
    v_rcp_f32 v52, v24
    v_mul_f32 v50, 0x40490fdb, v24
    v_cvt_pk_bf16_f32 v50, v50, v50
    v_and_b32 v50, s28, v50
    v_mul_f32 v50, 0x3e4ccccd, v50
    v_cvt_pk_bf16_f32 v50, v50, v50
    v_and_b32 v50, s28, v50
    v_mul_f32 v50, 0.15915494, v50
    v_cos_f32 v50, v50
    s_nop 0
    v_cvt_pk_bf16_f32 v50, v50, v50
    v_and_b32 v50, s28, v50
    v_add_f32 v50, 1.0, v50
    v_cvt_pk_bf16_f32 v50, v50, v50
    v_and_b32 v50, s28, v50
    v_mul_f32 v52, 0.5, v52
    v_mul_f32 v50, v50, v52
    v_cmp_lt_f32 vcc, 0, v24
    v_mul_f32 v54, v24, v2
    v_cvt_pk_bf16_f32 v54, v54, v54
    v_and_b32 v54, s28, v54
    v_cndmask_b32 v50, 0, v50, vcc
    v_mul_f32 v54, 0.15915494, v54
    v_sin_f32 v54, v54
    s_nop 0
    v_mul_f32 v54, v54, v50
    v_rcp_f32 v53, v25
    v_mul_f32 v51, 0x40490fdb, v25
    v_cvt_pk_bf16_f32 v51, v51, v51
    v_and_b32 v51, s28, v51
    v_mul_f32 v51, 0x3e4ccccd, v51
    v_cvt_pk_bf16_f32 v51, v51, v51
    v_and_b32 v51, s28, v51
    v_mul_f32 v51, 0.15915494, v51
    v_cos_f32 v51, v51
    s_nop 0
    v_cvt_pk_bf16_f32 v51, v51, v51
    v_and_b32 v51, s28, v51
    v_add_f32 v51, 1.0, v51
    v_cvt_pk_bf16_f32 v51, v51, v51
    v_and_b32 v51, s28, v51
    v_mul_f32 v53, 0.5, v53
    v_mul_f32 v51, v51, v53
    v_cmp_lt_f32 vcc, 0, v25
    v_mul_f32 v55, v25, v2
    v_cvt_pk_bf16_f32 v55, v55, v55
    v_and_b32 v55, s28, v55
    v_cndmask_b32 v51, 0, v51, vcc
    v_mul_f32 v55, 0.15915494, v55
    v_sin_f32 v55, v55
    s_nop 0
    v_mul_f32 v55, v55, v51
    v_cvt_pk_bf16_f32 v56, v54, v55
    v_rcp_f32 v52, v26
    v_mul_f32 v50, 0x40490fdb, v26
    v_cvt_pk_bf16_f32 v50, v50, v50
    v_and_b32 v50, s28, v50
    v_mul_f32 v50, 0x3e4ccccd, v50
    v_cvt_pk_bf16_f32 v50, v50, v50
    v_and_b32 v50, s28, v50
    v_mul_f32 v50, 0.15915494, v50
    v_cos_f32 v50, v50
    s_nop 0
    v_cvt_pk_bf16_f32 v50, v50, v50
    v_and_b32 v50, s28, v50
    v_add_f32 v50, 1.0, v50
    v_cvt_pk_bf16_f32 v50, v50, v50
    v_and_b32 v50, s28, v50
    v_mul_f32 v52, 0.5, v52
    v_mul_f32 v50, v50, v52
    v_cmp_lt_f32 vcc, 0, v26
    v_mul_f32 v54, v26, v2
    v_cvt_pk_bf16_f32 v54, v54, v54
    v_and_b32 v54, s28, v54
    v_cndmask_b32 v50, 0, v50, vcc
    v_mul_f32 v54, 0.15915494, v54
    v_sin_f32 v54, v54
    s_nop 0
    v_mul_f32 v54, v54, v50
    v_rcp_f32 v53, v27
    v_mul_f32 v51, 0x40490fdb, v27
    v_cvt_pk_bf16_f32 v51, v51, v51
    v_and_b32 v51, s28, v51
    v_mul_f32 v51, 0x3e4ccccd, v51
    v_cvt_pk_bf16_f32 v51, v51, v51
    v_and_b32 v51, s28, v51
    v_mul_f32 v51, 0.15915494, v51
    v_cos_f32 v51, v51
    s_nop 0
    v_cvt_pk_bf16_f32 v51, v51, v51
    v_and_b32 v51, s28, v51
    v_add_f32 v51, 1.0, v51
    v_cvt_pk_bf16_f32 v51, v51, v51
    v_and_b32 v51, s28, v51
    v_mul_f32 v53, 0.5, v53
    v_mul_f32 v51, v51, v53
    v_cmp_lt_f32 vcc, 0, v27
    v_mul_f32 v55, v27, v2
    v_cvt_pk_bf16_f32 v55, v55, v55
    v_and_b32 v55, s28, v55
    v_cndmask_b32 v51, 0, v51, vcc
    v_mul_f32 v55, 0.15915494, v55
    v_sin_f32 v55, v55
    s_nop 0
    v_mul_f32 v55, v55, v51
    v_cvt_pk_bf16_f32 v57, v54, v55
    v_rcp_f32 v52, v28
    v_mul_f32 v50, 0x40490fdb, v28
    v_cvt_pk_bf16_f32 v50, v50, v50
    v_and_b32 v50, s28, v50
    v_mul_f32 v50, 0x3e4ccccd, v50
    v_cvt_pk_bf16_f32 v50, v50, v50
    v_and_b32 v50, s28, v50
    v_mul_f32 v50, 0.15915494, v50
    v_cos_f32 v50, v50
    s_nop 0
    v_cvt_pk_bf16_f32 v50, v50, v50
    v_and_b32 v50, s28, v50
    v_add_f32 v50, 1.0, v50
    v_cvt_pk_bf16_f32 v50, v50, v50
    v_and_b32 v50, s28, v50
    v_mul_f32 v52, 0.5, v52
    v_mul_f32 v50, v50, v52
    v_cmp_lt_f32 vcc, 0, v28
    v_mul_f32 v54, v28, v2
    v_cvt_pk_bf16_f32 v54, v54, v54
    v_and_b32 v54, s28, v54
    v_cndmask_b32 v50, 0, v50, vcc
    v_mul_f32 v54, 0.15915494, v54
    v_sin_f32 v54, v54
    s_nop 0
    v_mul_f32 v54, v54, v50
    v_rcp_f32 v53, v29
    v_mul_f32 v51, 0x40490fdb, v29
    v_cvt_pk_bf16_f32 v51, v51, v51
    v_and_b32 v51, s28, v51
    v_mul_f32 v51, 0x3e4ccccd, v51
    v_cvt_pk_bf16_f32 v51, v51, v51
    v_and_b32 v51, s28, v51
    v_mul_f32 v51, 0.15915494, v51
    v_cos_f32 v51, v51
    s_nop 0
    v_cvt_pk_bf16_f32 v51, v51, v51
    v_and_b32 v51, s28, v51
    v_add_f32 v51, 1.0, v51
    v_cvt_pk_bf16_f32 v51, v51, v51
    v_and_b32 v51, s28, v51
    v_mul_f32 v53, 0.5, v53
    v_mul_f32 v51, v51, v53
    v_cmp_lt_f32 vcc, 0, v29
    v_mul_f32 v55, v29, v2
    v_cvt_pk_bf16_f32 v55, v55, v55
    v_and_b32 v55, s28, v55
    v_cndmask_b32 v51, 0, v51, vcc
    v_mul_f32 v55, 0.15915494, v55
    v_sin_f32 v55, v55
    s_nop 0
    v_mul_f32 v55, v55, v51
    v_cvt_pk_bf16_f32 v58, v54, v55
    v_rcp_f32 v52, v30
    v_mul_f32 v50, 0x40490fdb, v30
    v_cvt_pk_bf16_f32 v50, v50, v50
    v_and_b32 v50, s28, v50
    v_mul_f32 v50, 0x3e4ccccd, v50
    v_cvt_pk_bf16_f32 v50, v50, v50
    v_and_b32 v50, s28, v50
    v_mul_f32 v50, 0.15915494, v50
    v_cos_f32 v50, v50
    s_nop 0
    v_cvt_pk_bf16_f32 v50, v50, v50
    v_and_b32 v50, s28, v50
    v_add_f32 v50, 1.0, v50
    v_cvt_pk_bf16_f32 v50, v50, v50
    v_and_b32 v50, s28, v50
    v_mul_f32 v52, 0.5, v52
    v_mul_f32 v50, v50, v52
    v_cmp_lt_f32 vcc, 0, v30
    v_mul_f32 v54, v30, v2
    v_cvt_pk_bf16_f32 v54, v54, v54
    v_and_b32 v54, s28, v54
    v_cndmask_b32 v50, 0, v50, vcc
    v_mul_f32 v54, 0.15915494, v54
    v_sin_f32 v54, v54
    s_nop 0
    v_mul_f32 v54, v54, v50
    v_rcp_f32 v53, v31
    v_mul_f32 v51, 0x40490fdb, v31
    v_cvt_pk_bf16_f32 v51, v51, v51
    v_and_b32 v51, s28, v51
    v_mul_f32 v51, 0x3e4ccccd, v51
    v_cvt_pk_bf16_f32 v51, v51, v51
    v_and_b32 v51, s28, v51
    v_mul_f32 v51, 0.15915494, v51
    v_cos_f32 v51, v51
    s_nop 0
    v_cvt_pk_bf16_f32 v51, v51, v51
    v_and_b32 v51, s28, v51
    v_add_f32 v51, 1.0, v51
    v_cvt_pk_bf16_f32 v51, v51, v51
    v_and_b32 v51, s28, v51
    v_mul_f32 v53, 0.5, v53
    v_mul_f32 v51, v51, v53
    v_cmp_lt_f32 vcc, 0, v31
    v_mul_f32 v55, v31, v2
    v_cvt_pk_bf16_f32 v55, v55, v55
    v_and_b32 v55, s28, v55
    v_cndmask_b32 v51, 0, v51, vcc
    v_mul_f32 v55, 0.15915494, v55
    v_sin_f32 v55, v55
    s_nop 0
    v_mul_f32 v55, v55, v51
    v_cvt_pk_bf16_f32 v59, v54, v55
    ds_read_b128 v[24:27], v21 offset:512
    ds_read_b128 v[28:31], v21 offset:528
    ds_read_b128 v[32:35], v21 offset:1024
    ds_read_b128 v[36:39], v21 offset:1040
    ds_read_b128 v[40:43], v21 offset:1536
    ds_read_b128 v[44:47], v21 offset:1552
    ds_read_b128 v[16:19], v6
    s_waitcnt lgkmcnt(1)
K2_G1_R:
    v_lshlrev_b32 v50, 16, v56
    v_and_b32 v51, s28, v56
    v_pk_mul_f32 v[52:53], v[50:51], v[24:25]
    v_cvt_pk_bf16_f32 v60, v52, v53
    v_pk_mul_f32 v[54:55], v[50:51], v[32:33]
    v_cvt_pk_bf16_f32 v64, v54, v55
    v_pk_mul_f32 v[52:53], v[50:51], v[40:41]
    v_cvt_pk_bf16_f32 v68, v52, v53
    v_lshlrev_b32 v50, 16, v57
    v_and_b32 v51, s28, v57
    v_pk_mul_f32 v[52:53], v[50:51], v[26:27]
    v_cvt_pk_bf16_f32 v61, v52, v53
    v_pk_mul_f32 v[54:55], v[50:51], v[34:35]
    v_cvt_pk_bf16_f32 v65, v54, v55
    v_pk_mul_f32 v[52:53], v[50:51], v[42:43]
    v_cvt_pk_bf16_f32 v69, v52, v53
    v_lshlrev_b32 v50, 16, v58
    v_and_b32 v51, s28, v58
    v_pk_mul_f32 v[52:53], v[50:51], v[28:29]
    v_cvt_pk_bf16_f32 v62, v52, v53
    v_pk_mul_f32 v[54:55], v[50:51], v[36:37]
    v_cvt_pk_bf16_f32 v66, v54, v55
    v_pk_mul_f32 v[52:53], v[50:51], v[44:45]
    v_cvt_pk_bf16_f32 v70, v52, v53
    v_lshlrev_b32 v50, 16, v59
    v_and_b32 v51, s28, v59
    v_pk_mul_f32 v[52:53], v[50:51], v[30:31]
    v_cvt_pk_bf16_f32 v63, v52, v53
    v_pk_mul_f32 v[54:55], v[50:51], v[38:39]
    v_cvt_pk_bf16_f32 v67, v54, v55
    v_pk_mul_f32 v[52:53], v[50:51], v[46:47]
    v_cvt_pk_bf16_f32 v71, v52, v53
    s_waitcnt vmcnt(8)
    v_perm_b32 v24, v76, v72, s29
    v_perm_b32 v25, v84, v80, s29
    v_perm_b32 v26, v92, v88, s29
    v_perm_b32 v27, v100, v96, s29
    v_perm_b32 v28, v76, v72, s30
    v_perm_b32 v29, v84, v80, s30
    v_perm_b32 v30, v92, v88, s30
    v_perm_b32 v31, v100, v96, s30
    v_mfma_f32_16x16x32_bf16 v[136:139], v[56:59], v[24:27], v[136:139]
    v_perm_b32 v32, v77, v73, s29
    v_perm_b32 v33, v85, v81, s29
    v_perm_b32 v34, v93, v89, s29
    v_perm_b32 v35, v101, v97, s29
    v_mfma_f32_16x16x32_bf16 v[140:143], v[56:59], v[28:31], v[140:143]
    v_perm_b32 v36, v77, v73, s30
    v_perm_b32 v37, v85, v81, s30
    v_perm_b32 v38, v93, v89, s30
    v_perm_b32 v39, v101, v97, s30
    v_mfma_f32_16x16x32_bf16 v[144:147], v[56:59], v[32:35], v[144:147]
    v_perm_b32 v24, v78, v74, s29
    v_perm_b32 v25, v86, v82, s29
    v_perm_b32 v26, v94, v90, s29
    v_perm_b32 v27, v102, v98, s29
    v_mfma_f32_16x16x32_bf16 v[148:151], v[56:59], v[36:39], v[148:151]
    v_perm_b32 v28, v78, v74, s30
    v_perm_b32 v29, v86, v82, s30
    v_perm_b32 v30, v94, v90, s30
    v_perm_b32 v31, v102, v98, s30
    v_mfma_f32_16x16x32_bf16 v[152:155], v[56:59], v[24:27], v[152:155]
    v_perm_b32 v32, v79, v75, s29
    v_perm_b32 v33, v87, v83, s29
    v_perm_b32 v34, v95, v91, s29
    v_perm_b32 v35, v103, v99, s29
    v_mfma_f32_16x16x32_bf16 v[156:159], v[56:59], v[28:31], v[156:159]
    v_perm_b32 v36, v79, v75, s30
    v_perm_b32 v37, v87, v83, s30
    v_perm_b32 v38, v95, v91, s30
    v_perm_b32 v39, v103, v99, s30
    v_mfma_f32_16x16x32_bf16 v[160:163], v[56:59], v[32:35], v[160:163]
    s_waitcnt lgkmcnt(0)
    v_mad_u32_u16 v40, v16, s31, v1 op_sel:[0,0,0,0]
    v_mad_u32_u16 v41, v16, s31, v1 op_sel:[1,0,0,0]
    v_mfma_f32_16x16x32_bf16 v[164:167], v[56:59], v[36:39], v[164:167]
    v_mad_u32_u16 v42, v17, s31, v1 op_sel:[0,0,0,0]
    v_mad_u32_u16 v43, v17, s31, v1 op_sel:[1,0,0,0]
    v_mad_u32_u16 v44, v18, s31, v1 op_sel:[0,0,0,0]
    v_mad_u32_u16 v45, v18, s31, v1 op_sel:[1,0,0,0]
    v_mad_u32_u16 v46, v19, s31, v1 op_sel:[0,0,0,0]
    v_mad_u32_u16 v47, v19, s31, v1 op_sel:[1,0,0,0]
    buffer_load_dwordx4 v[72:75], v40, s[12:15], 0 offen
    buffer_load_dwordx4 v[76:79], v41, s[12:15], 0 offen
    buffer_load_dwordx4 v[80:83], v42, s[12:15], 0 offen
    buffer_load_dwordx4 v[84:87], v43, s[12:15], 0 offen
    buffer_load_dwordx4 v[88:91], v44, s[12:15], 0 offen
    buffer_load_dwordx4 v[92:95], v45, s[12:15], 0 offen
    buffer_load_dwordx4 v[96:99], v46, s[12:15], 0 offen
    buffer_load_dwordx4 v[100:103], v47, s[12:15], 0 offen
    s_waitcnt vmcnt(8)
    v_perm_b32 v24, v110, v106, s29
    v_perm_b32 v25, v118, v114, s29
    v_perm_b32 v26, v126, v122, s29
    v_perm_b32 v27, v134, v130, s29
    v_perm_b32 v28, v110, v106, s30
    v_perm_b32 v29, v118, v114, s30
    v_mfma_f32_16x16x32_bf16 v[184:187], v[24:27], v[56:59], v[184:187]
    v_perm_b32 v30, v126, v122, s30
    v_mfma_f32_16x16x32_bf16 v[200:203], v[24:27], v[60:63], v[200:203]
    v_perm_b32 v31, v134, v130, s30
    v_mfma_f32_16x16x32_bf16 v[216:219], v[24:27], v[64:67], v[216:219]
    v_mfma_f32_16x16x32_bf16 v[232:235], v[24:27], v[68:71], v[232:235]
    v_perm_b32 v32, v111, v107, s29
    v_perm_b32 v33, v119, v115, s29
    v_mfma_f32_16x16x32_bf16 v[188:191], v[28:31], v[56:59], v[188:191]
    v_perm_b32 v34, v127, v123, s29
    v_mfma_f32_16x16x32_bf16 v[204:207], v[28:31], v[60:63], v[204:207]
    v_perm_b32 v35, v135, v131, s29
    v_mfma_f32_16x16x32_bf16 v[220:223], v[28:31], v[64:67], v[220:223]
    v_mfma_f32_16x16x32_bf16 v[236:239], v[28:31], v[68:71], v[236:239]
    v_perm_b32 v36, v111, v107, s30
    v_perm_b32 v37, v119, v115, s30
    v_mfma_f32_16x16x32_bf16 v[192:195], v[32:35], v[56:59], v[192:195]
    v_perm_b32 v38, v127, v123, s30
    v_mfma_f32_16x16x32_bf16 v[208:211], v[32:35], v[60:63], v[208:211]
    v_perm_b32 v39, v135, v131, s30
    v_mfma_f32_16x16x32_bf16 v[224:227], v[32:35], v[64:67], v[224:227]
    v_mfma_f32_16x16x32_bf16 v[240:243], v[32:35], v[68:71], v[240:243]
    v_perm_b32 v24, v108, v104, s29
    v_perm_b32 v25, v116, v112, s29
    v_mfma_f32_16x16x32_bf16 v[196:199], v[36:39], v[56:59], v[196:199]
    v_perm_b32 v26, v124, v120, s29
    v_mfma_f32_16x16x32_bf16 v[212:215], v[36:39], v[60:63], v[212:215]
    v_perm_b32 v27, v132, v128, s29
    v_mfma_f32_16x16x32_bf16 v[228:231], v[36:39], v[64:67], v[228:231]
    v_mfma_f32_16x16x32_bf16 v[244:247], v[36:39], v[68:71], v[244:247]
    v_perm_b32 v28, v108, v104, s30
    v_perm_b32 v29, v116, v112, s30
    v_perm_b32 v30, v124, v120, s30
    v_perm_b32 v31, v132, v128, s30
    v_mfma_f32_16x16x32_bf16 v[168:171], v[56:59], v[24:27], v[168:171]
    v_perm_b32 v32, v109, v105, s29
    v_perm_b32 v33, v117, v113, s29
    v_perm_b32 v34, v125, v121, s29
    v_perm_b32 v35, v133, v129, s29
    v_mfma_f32_16x16x32_bf16 v[172:175], v[56:59], v[28:31], v[172:175]
    v_perm_b32 v36, v109, v105, s30
    v_perm_b32 v37, v117, v113, s30
    v_perm_b32 v38, v125, v121, s30
    v_perm_b32 v39, v133, v129, s30
    v_mfma_f32_16x16x32_bf16 v[176:179], v[56:59], v[32:35], v[176:179]
    buffer_load_dwordx4 v[104:107], v40, s[12:15], 0 offen offset:256
    buffer_load_dwordx4 v[108:111], v41, s[12:15], 0 offen offset:256
    v_mfma_f32_16x16x32_bf16 v[180:183], v[56:59], v[36:39], v[180:183]
    buffer_load_dwordx4 v[112:115], v42, s[12:15], 0 offen offset:256
    buffer_load_dwordx4 v[116:119], v43, s[12:15], 0 offen offset:256
    buffer_load_dwordx4 v[120:123], v44, s[12:15], 0 offen offset:256
    buffer_load_dwordx4 v[124:127], v45, s[12:15], 0 offen offset:256
    buffer_load_dwordx4 v[128:131], v46, s[12:15], 0 offen offset:256
    buffer_load_dwordx4 v[132:135], v47, s[12:15], 0 offen offset:256
    s_mov_b32 s39, s40
    v_add_u32 v5, 128, v5
    v_add_u32 v21, 128, v21
    s_cmp_eq_u32 s42, 1
    s_cbranch_scc0 K2_STEP
K2_EPI:
    s_nop 11
    ds_read_b128 v[24:27], v12 offset:0
    ds_read_b128 v[28:31], v12 offset:1024
    ds_read_b128 v[32:35], v12 offset:2048
    ds_read_b128 v[36:39], v12 offset:3072
    ds_read_b128 v[40:43], v12 offset:4096
    ds_read_b128 v[44:47], v12 offset:5120
    ds_read_b128 v[48:51], v12 offset:6144
    ds_read_b128 v[52:55], v12 offset:7168
    v_cvt_pk_bf16_f32 v184, v184, v185
    v_cvt_pk_bf16_f32 v185, v186, v187
    v_cvt_pk_bf16_f32 v186, v188, v189
    v_cvt_pk_bf16_f32 v187, v190, v191
    v_cvt_pk_bf16_f32 v192, v192, v193
    v_cvt_pk_bf16_f32 v193, v194, v195
    v_cvt_pk_bf16_f32 v194, v196, v197
    v_cvt_pk_bf16_f32 v195, v198, v199
    v_cvt_pk_bf16_f32 v200, v200, v201
    v_cvt_pk_bf16_f32 v201, v202, v203
    v_cvt_pk_bf16_f32 v202, v204, v205
    v_cvt_pk_bf16_f32 v203, v206, v207
    v_cvt_pk_bf16_f32 v208, v208, v209
    v_cvt_pk_bf16_f32 v209, v210, v211
    v_cvt_pk_bf16_f32 v210, v212, v213
    v_cvt_pk_bf16_f32 v211, v214, v215
    v_cvt_pk_bf16_f32 v216, v216, v217
    v_cvt_pk_bf16_f32 v217, v218, v219
    v_cvt_pk_bf16_f32 v218, v220, v221
    v_cvt_pk_bf16_f32 v219, v222, v223
    v_cvt_pk_bf16_f32 v224, v224, v225
    v_cvt_pk_bf16_f32 v225, v226, v227
    v_cvt_pk_bf16_f32 v226, v228, v229
    v_cvt_pk_bf16_f32 v227, v230, v231
    v_cvt_pk_bf16_f32 v232, v232, v233
    v_cvt_pk_bf16_f32 v233, v234, v235
    v_cvt_pk_bf16_f32 v234, v236, v237
    v_cvt_pk_bf16_f32 v235, v238, v239
    v_cvt_pk_bf16_f32 v240, v240, v241
    v_cvt_pk_bf16_f32 v241, v242, v243
    v_cvt_pk_bf16_f32 v242, v244, v245
    v_cvt_pk_bf16_f32 v243, v246, v247
    ds_read_b128 v[188:191], v12 offset:20480
    ds_read_b128 v[196:199], v12 offset:21504
    ds_read_b128 v[204:207], v12 offset:22528
    ds_read_b128 v[212:215], v12 offset:23552
    s_waitcnt lgkmcnt(4)
    v_mfma_f32_16x16x32_bf16 v[56:59], v[184:187], v[24:27], 0
    v_mfma_f32_16x16x32_bf16 v[60:63], v[184:187], v[28:31], 0
    v_mfma_f32_16x16x32_bf16 v[64:67], v[184:187], v[32:35], 0
    v_mfma_f32_16x16x32_bf16 v[68:71], v[184:187], v[36:39], 0
    v_mfma_f32_16x16x32_bf16 v[56:59], v[192:195], v[40:43], v[56:59]
    v_mfma_f32_16x16x32_bf16 v[60:63], v[192:195], v[44:47], v[60:63]
    v_mfma_f32_16x16x32_bf16 v[64:67], v[192:195], v[48:51], v[64:67]
    v_mfma_f32_16x16x32_bf16 v[68:71], v[192:195], v[52:55], v[68:71]
    ds_read_b128 v[24:27], v12 offset:8192
    ds_read_b128 v[28:31], v12 offset:9216
    ds_read_b128 v[32:35], v12 offset:10240
    ds_read_b128 v[36:39], v12 offset:11264
    ds_read_b128 v[40:43], v12 offset:12288
    ds_read_b128 v[44:47], v12 offset:13312
    ds_read_b128 v[48:51], v12 offset:14336
    ds_read_b128 v[52:55], v12 offset:15360
    s_waitcnt lgkmcnt(8)
    v_mul_f32 v228, v188, v136
    v_mul_f32 v229, v196, v140
    v_mul_f32 v230, v204, v144
    v_mul_f32 v231, v212, v148
    v_fmac_f32 v228, v189, v137
    v_fmac_f32 v229, v197, v141
    v_fmac_f32 v230, v205, v145
    v_fmac_f32 v231, v213, v149
    v_fmac_f32 v228, v190, v138
    v_fmac_f32 v229, v198, v142
    v_fmac_f32 v230, v206, v146
    v_fmac_f32 v231, v214, v150
    v_fmac_f32 v228, v191, v139
    v_fmac_f32 v229, v199, v143
    v_fmac_f32 v230, v207, v147
    v_fmac_f32 v231, v215, v151
    v_mul_f32 v236, v188, v152
    v_mul_f32 v237, v196, v156
    v_mul_f32 v238, v204, v160
    v_mul_f32 v239, v212, v164
    v_fmac_f32 v236, v189, v153
    v_fmac_f32 v237, v197, v157
    v_fmac_f32 v238, v205, v161
    v_fmac_f32 v239, v213, v165
    v_fmac_f32 v236, v190, v154
    v_fmac_f32 v237, v198, v158
    v_fmac_f32 v238, v206, v162
    v_fmac_f32 v239, v214, v166
    v_fmac_f32 v236, v191, v155
    v_fmac_f32 v237, v199, v159
    v_fmac_f32 v238, v207, v163
    v_fmac_f32 v239, v215, v167
    v_mul_f32 v244, v188, v168
    v_mul_f32 v245, v196, v172
    v_mul_f32 v246, v204, v176
    v_mul_f32 v247, v212, v180
    v_fmac_f32 v244, v189, v169
    v_fmac_f32 v245, v197, v173
    v_fmac_f32 v246, v205, v177
    v_fmac_f32 v247, v213, v181
    v_fmac_f32 v244, v190, v170
    v_fmac_f32 v245, v198, v174
    v_fmac_f32 v246, v206, v178
    v_fmac_f32 v247, v214, v182
    v_fmac_f32 v244, v191, v171
    v_fmac_f32 v245, v199, v175
    v_fmac_f32 v246, v207, v179
    v_fmac_f32 v247, v215, v183
    ds_read_b128 v[188:191], v12 offset:16384
    ds_read_b128 v[196:199], v12 offset:17408
    ds_read_b128 v[204:207], v12 offset:18432
    ds_read_b128 v[212:215], v12 offset:19456
    s_waitcnt lgkmcnt(4)
    v_mfma_f32_16x16x32_bf16 v[136:139], v[200:203], v[24:27], 0
    v_mfma_f32_16x16x32_bf16 v[140:143], v[200:203], v[28:31], 0
    v_mfma_f32_16x16x32_bf16 v[144:147], v[200:203], v[32:35], 0
    v_mfma_f32_16x16x32_bf16 v[148:151], v[200:203], v[36:39], 0
    v_mfma_f32_16x16x32_bf16 v[136:139], v[208:211], v[40:43], v[136:139]
    v_mfma_f32_16x16x32_bf16 v[140:143], v[208:211], v[44:47], v[140:143]
    v_mfma_f32_16x16x32_bf16 v[144:147], v[208:211], v[48:51], v[144:147]
    v_mfma_f32_16x16x32_bf16 v[148:151], v[208:211], v[52:55], v[148:151]
    v_mfma_f32_16x16x32_bf16 v[152:155], v[216:219], v[24:27], 0
    v_mfma_f32_16x16x32_bf16 v[156:159], v[216:219], v[28:31], 0
    v_mfma_f32_16x16x32_bf16 v[160:163], v[216:219], v[32:35], 0
    v_mfma_f32_16x16x32_bf16 v[164:167], v[216:219], v[36:39], 0
    v_mfma_f32_16x16x32_bf16 v[152:155], v[224:227], v[40:43], v[152:155]
    v_mfma_f32_16x16x32_bf16 v[156:159], v[224:227], v[44:47], v[156:159]
    v_mfma_f32_16x16x32_bf16 v[160:163], v[224:227], v[48:51], v[160:163]
    v_mfma_f32_16x16x32_bf16 v[164:167], v[224:227], v[52:55], v[164:167]
    v_mfma_f32_16x16x32_bf16 v[168:171], v[232:235], v[24:27], 0
    v_mfma_f32_16x16x32_bf16 v[172:175], v[232:235], v[28:31], 0
    v_mfma_f32_16x16x32_bf16 v[176:179], v[232:235], v[32:35], 0
    v_mfma_f32_16x16x32_bf16 v[180:183], v[232:235], v[36:39], 0
    v_mfma_f32_16x16x32_bf16 v[168:171], v[240:243], v[40:43], v[168:171]
    v_mfma_f32_16x16x32_bf16 v[172:175], v[240:243], v[44:47], v[172:175]
    v_mfma_f32_16x16x32_bf16 v[176:179], v[240:243], v[48:51], v[176:179]
    v_mfma_f32_16x16x32_bf16 v[180:183], v[240:243], v[52:55], v[180:183]
    s_waitcnt lgkmcnt(0)
    v_mul_f32 v220, v188, v56
    v_mul_f32 v221, v196, v60
    v_mul_f32 v222, v204, v64
    v_mul_f32 v223, v212, v68
    v_fmac_f32 v220, v189, v57
    v_fmac_f32 v221, v197, v61
    v_fmac_f32 v222, v205, v65
    v_fmac_f32 v223, v213, v69
    v_fmac_f32 v220, v190, v58
    v_fmac_f32 v221, v198, v62
    v_fmac_f32 v222, v206, v66
    v_fmac_f32 v223, v214, v70
    v_fmac_f32 v220, v191, v59
    v_fmac_f32 v221, v199, v63
    v_fmac_f32 v222, v207, v67
    v_fmac_f32 v223, v215, v71
    ds_read_b128 v[188:191], v12 offset:24576
    ds_read_b128 v[196:199], v12 offset:25600
    ds_read_b128 v[204:207], v12 offset:26624
    ds_read_b128 v[212:215], v12 offset:27648
    s_waitcnt lgkmcnt(0)
    v_fmac_f32 v228, v188, v136
    v_fmac_f32 v229, v196, v140
    v_fmac_f32 v230, v204, v144
    v_fmac_f32 v231, v212, v148
    v_fmac_f32 v228, v189, v137
    v_fmac_f32 v229, v197, v141
    v_fmac_f32 v230, v205, v145
    v_fmac_f32 v231, v213, v149
    v_fmac_f32 v228, v190, v138
    v_fmac_f32 v229, v198, v142
    v_fmac_f32 v230, v206, v146
    v_fmac_f32 v231, v214, v150
    v_fmac_f32 v228, v191, v139
    v_fmac_f32 v229, v199, v143
    v_fmac_f32 v230, v207, v147
    v_fmac_f32 v231, v215, v151
    v_fmac_f32 v236, v188, v152
    v_fmac_f32 v237, v196, v156
    v_fmac_f32 v238, v204, v160
    v_fmac_f32 v239, v212, v164
    v_fmac_f32 v236, v189, v153
    v_fmac_f32 v237, v197, v157
    v_fmac_f32 v238, v205, v161
    v_fmac_f32 v239, v213, v165
    v_fmac_f32 v236, v190, v154
    v_fmac_f32 v237, v198, v158
    v_fmac_f32 v238, v206, v162
    v_fmac_f32 v239, v214, v166
    v_fmac_f32 v236, v191, v155
    v_fmac_f32 v237, v199, v159
    v_fmac_f32 v238, v207, v163
    v_fmac_f32 v239, v215, v167
    v_fmac_f32 v244, v188, v168
    v_fmac_f32 v245, v196, v172
    v_fmac_f32 v246, v204, v176
    v_fmac_f32 v247, v212, v180
    v_fmac_f32 v244, v189, v169
    v_fmac_f32 v245, v197, v173
    v_fmac_f32 v246, v205, v177
    v_fmac_f32 v247, v213, v181
    v_fmac_f32 v244, v190, v170
    v_fmac_f32 v245, v198, v174
    v_fmac_f32 v246, v206, v178
    v_fmac_f32 v247, v214, v182
    v_fmac_f32 v244, v191, v171
    v_fmac_f32 v245, v199, v175
    v_fmac_f32 v246, v207, v179
    v_fmac_f32 v247, v215, v183
    v_permlane32_swap_b32 v220, v222
    v_permlane32_swap_b32 v221, v223
    v_permlane32_swap_b32 v228, v230
    v_permlane32_swap_b32 v229, v231
    v_permlane32_swap_b32 v236, v238
    v_permlane32_swap_b32 v237, v239
    v_permlane32_swap_b32 v244, v246
    v_permlane32_swap_b32 v245, v247
    v_add_f32 v220, v220, v222
    v_add_f32 v221, v221, v223
    v_add_f32 v228, v228, v230
    v_add_f32 v229, v229, v231
    v_add_f32 v236, v236, v238
    v_add_f32 v237, v237, v239
    v_add_f32 v244, v244, v246
    v_add_f32 v245, v245, v247
    v_permlane16_swap_b32 v220, v221
    v_permlane16_swap_b32 v228, v229
    v_permlane16_swap_b32 v236, v237
    v_permlane16_swap_b32 v244, v245
    v_add_f32 v220, v220, v221
    v_add_f32 v228, v228, v229
    v_add_f32 v236, v236, v237
    v_add_f32 v244, v244, v245
    s_add_u32 s52, s32, s34
    s_and_b32 s53, s48, s49
    s_cmp_eq_u32 s53, 1
    s_cbranch_scc1 K2_EPI_FINAL
    s_lshl_b32 s53, s52, 10
    s_add_u32 s53, s53, 20971520
    v_lshlrev_b32 v13, 2, v22
    s_cmp_eq_u32 s48, 1
    s_cbranch_scc1 K2_EPI_NOLOAD
    buffer_load_dword v56, v13, s[16:19], s53 offen offset:0
    buffer_load_dword v57, v13, s[16:19], s53 offen offset:256
    buffer_load_dword v58, v13, s[16:19], s53 offen offset:512
    buffer_load_dword v59, v13, s[16:19], s53 offen offset:768
    s_waitcnt vmcnt(0)
    v_add_f32 v220, v220, v56
    v_add_f32 v228, v228, v57
    v_add_f32 v236, v236, v58
    v_add_f32 v244, v244, v59
K2_EPI_NOLOAD:
    s_cmp_eq_u32 s49, 1
    s_cbranch_scc1 K2_EPI_FINAL
    buffer_store_dword v220, v13, s[16:19], s53 offen offset:0
    buffer_store_dword v228, v13, s[16:19], s53 offen offset:256
    buffer_store_dword v236, v13, s[16:19], s53 offen offset:512
    buffer_store_dword v244, v13, s[16:19], s53 offen offset:768
    s_waitcnt vmcnt(0)
    s_branch K2_EPI_DONE
K2_EPI_FINAL:
    v_cvt_pk_bf16_f32 v56, v220, v228
    v_cvt_pk_bf16_f32 v57, v236, v244
    v_lshlrev_b32 v58, 16, v56
    v_and_b32 v59, s28, v56
    v_lshlrev_b32 v60, 16, v57
    v_and_b32 v61, s28, v57
    v_add_f32 v58, v58, v8
    v_add_f32 v59, v59, v9
    v_add_f32 v60, v60, v10
    v_add_f32 v61, v61, v11
    v_cvt_pk_bf16_f32 v56, v58, v59
    v_cvt_pk_bf16_f32 v57, v60, v61
    s_lshl_b32 s53, s52, 9
    buffer_store_short v56, v7, s[24:27], s53 offen nt
    buffer_store_short_d16_hi v56, v7, s[24:27], s53 offen offset:128 nt
    buffer_store_short v57, v7, s[24:27], s53 offen offset:256 nt
    buffer_store_short_d16_hi v57, v7, s[24:27], s53 offen offset:384 nt
K2_EPI_DONE:
    s_add_u32 s52, s32, s36
    s_lshl_b32 s52, s52, 9
    buffer_load_short_d16_hi v8, v7, s[20:23], s52 offen offset:0 nt
    buffer_load_short_d16_hi v9, v7, s[20:23], s52 offen offset:128 nt
    buffer_load_short_d16_hi v10, v7, s[20:23], s52 offen offset:256 nt
    buffer_load_short_d16_hi v11, v7, s[20:23], s52 offen offset:384 nt
    s_min_u32 s34, s36, 49
    s_lshl_b32 s52, s34, 8
    v_lshlrev_b32 v37, 1, v22
    v_add_u32 v37, s52, v37
    ds_read_u16 v24, v37
    ds_read_u16 v25, v37 offset:128
    s_add_u32 s52, s32, s34
    s_mul_i32 s52, s52, 6
    s_add_u32 s52, s52, 12800
    s_min_u32 s52, s52, 87794
    v_mov_b32 v38, s52
    v_mov_b32 v30, 0
    v_mov_b32 v31, 0
    v_mov_b32 v32, 0
    ds_read_u16_d16_hi v30, v38 offset:0
    ds_read_u16_d16_hi v31, v38 offset:2
    ds_read_u16_d16_hi v32, v38 offset:4
    s_mov_b32 s84, 0
    v_mov_b32 v34, 133632
    v_mov_b32 v36, 0
    s_waitcnt lgkmcnt(3)
    s_sub_i32 s53, s77, 0
    v_cmp_gt_i32 s[56:57], s53, v22
    s_nop 1
    v_cndmask_b32 v24, 0, v24, s[56:57]
    v_mul_u32_u24 v37, 6, v24
    v_and_b32 v37, -4, v37
    v_add_u32 v37, 12800, v37
    ds_read2_b32 v[26:27], v37 offset0:0 offset1:1
    v_and_b32 v24, 1, v24
    v_lshlrev_b32 v24, 4, v24
    s_sub_i32 s53, s77, 64
    v_cmp_gt_i32 s[58:59], s53, v22
    s_nop 1
    v_cndmask_b32 v25, 0, v25, s[58:59]
    v_mul_u32_u24 v37, 6, v25
    v_and_b32 v37, -4, v37
    v_add_u32 v37, 12800, v37
    ds_read2_b32 v[28:29], v37 offset0:0 offset1:1
    v_and_b32 v25, 1, v25
    v_lshlrev_b32 v25, 4, v25
    s_waitcnt lgkmcnt(1)
    v_alignbit_b32 v40, v27, v26, v24
    v_lshrrev_b32 v41, v24, v27
    v_lshlrev_b32 v39, 16, v40
    v_and_b32 v40, s28, v40
    v_lshlrev_b32 v41, 16, v41
    v_sub_f32 v39, v39, v30
    v_sub_f32 v40, v40, v31
    v_sub_f32 v41, v41, v32
    v_cvt_pk_bf16_f32 v42, v39, v40
    v_lshlrev_b32 v39, 16, v42
    v_and_b32 v40, s28, v42
    v_cvt_pk_bf16_f32 v41, v41, v41
    v_and_b32 v41, s28, v41
    v_mul_f32 v43, v39, v39
    v_mul_f32 v44, v40, v40
    v_mul_f32 v45, v41, v41
    v_cvt_pk_bf16_f32 v42, v43, v44
    v_lshlrev_b32 v43, 16, v42
    v_and_b32 v44, s28, v42
    v_cvt_pk_bf16_f32 v45, v45, v45
    v_and_b32 v45, s28, v45
    v_add_f32 v46, v43, v44
    v_add_f32 v46, v46, v45
    v_cvt_pk_bf16_f32 v46, v46, v46
    v_and_b32 v46, s28, v46
    v_add_f32 v46, 0x322bcc77, v46
    v_cvt_pk_bf16_f32 v46, v46, v46
    v_and_b32 v46, s28, v46
    v_sqrt_f32 v46, v46
    s_nop 0
    v_cvt_pk_bf16_f32 v46, v46, v46
    v_and_b32 v46, s28, v46
    v_rcp_f32 v43, v46
    v_cmp_gt_f32 vcc, 0x40a00000, v46
    s_nop 0
    s_and_b64 s[54:55], vcc, s[56:57]
    v_lshrrev_b32 v44, 16, v46
    v_mul_f32 v39, v39, v43
    v_mul_f32 v40, v40, v43
    v_mul_f32 v41, v41, v43
    v_cmp_gt_u32 vcc, 15744, v44
    v_lshlrev_b32 v44, 5, v44
    v_add_u32 v44, -370144, v44
    s_and_b64 vcc, vcc, s[54:55]
    s_cmp_lg_u64 vcc, 0
    s_cselect_b32 s52, 1, 0
    s_or_b32 s84, s84, s52
    v_cvt_pk_bf16_f32 v42, v39, v40
    v_lshlrev_b32 v39, 16, v42
    v_and_b32 v40, s28, v42
    v_cvt_pk_bf16_f32 v41, v41, v41
    v_and_b32 v41, s28, v41
    v_mov_b32 v45, 133632
    v_cndmask_b32 v33, v45, v44, s[54:55]
    v_cndmask_b32 v35, 0, v46, s[54:55]
    v_lshl_add_u32 v37, v22, 2, v23
    ds_write_b32 v37, v39 offset:512
    ds_write_b32 v37, v40 offset:1024
    ds_write_b32 v37, v41 offset:1536
    s_cmp_le_u32 s77, 64
    s_cbranch_scc1 K2_GEO_W_E
    s_waitcnt lgkmcnt(0)
    v_alignbit_b32 v40, v29, v28, v25
    v_lshrrev_b32 v41, v25, v29
    v_lshlrev_b32 v39, 16, v40
    v_and_b32 v40, s28, v40
    v_lshlrev_b32 v41, 16, v41
    v_sub_f32 v39, v39, v30
    v_sub_f32 v40, v40, v31
    v_sub_f32 v41, v41, v32
    v_cvt_pk_bf16_f32 v42, v39, v40
    v_lshlrev_b32 v39, 16, v42
    v_and_b32 v40, s28, v42
    v_cvt_pk_bf16_f32 v41, v41, v41
    v_and_b32 v41, s28, v41
    v_mul_f32 v43, v39, v39
    v_mul_f32 v44, v40, v40
    v_mul_f32 v45, v41, v41
    v_cvt_pk_bf16_f32 v42, v43, v44
    v_lshlrev_b32 v43, 16, v42
    v_and_b32 v44, s28, v42
    v_cvt_pk_bf16_f32 v45, v45, v45
    v_and_b32 v45, s28, v45
    v_add_f32 v46, v43, v44
    v_add_f32 v46, v46, v45
    v_cvt_pk_bf16_f32 v46, v46, v46
    v_and_b32 v46, s28, v46
    v_add_f32 v46, 0x322bcc77, v46
    v_cvt_pk_bf16_f32 v46, v46, v46
    v_and_b32 v46, s28, v46
    v_sqrt_f32 v46, v46
    s_nop 0
    v_cvt_pk_bf16_f32 v46, v46, v46
    v_and_b32 v46, s28, v46
    v_rcp_f32 v43, v46
    v_cmp_gt_f32 vcc, 0x40a00000, v46
    s_nop 0
    s_and_b64 s[54:55], vcc, s[58:59]
    v_lshrrev_b32 v44, 16, v46
    v_mul_f32 v39, v39, v43
    v_mul_f32 v40, v40, v43
    v_mul_f32 v41, v41, v43
    v_cmp_gt_u32 vcc, 15744, v44
    v_lshlrev_b32 v44, 5, v44
    v_add_u32 v44, -370144, v44
    s_and_b64 vcc, vcc, s[54:55]
    s_cmp_lg_u64 vcc, 0
    s_cselect_b32 s52, 1, 0
    s_or_b32 s84, s84, s52
    v_cvt_pk_bf16_f32 v42, v39, v40
    v_lshlrev_b32 v39, 16, v42
    v_and_b32 v40, s28, v42
    v_cvt_pk_bf16_f32 v41, v41, v41
    v_and_b32 v41, s28, v41
    v_mov_b32 v45, 133632
    v_cndmask_b32 v34, v45, v44, s[54:55]
    v_cndmask_b32 v36, 0, v46, s[54:55]
    v_lshl_add_u32 v37, v22, 2, v23
    ds_write_b32 v37, v39 offset:768
    ds_write_b32 v37, v40 offset:1280
    ds_write_b32 v37, v41 offset:1792
K2_GEO_W_E:
    v_lshl_add_u32 v37, v22, 2, v23
    s_cmp_eq_u32 s84, 1
    s_cbranch_scc1 K2_GEO_S_E
    ds_write_b32 v37, v33
    ds_write_b32 v37, v34 offset:256
    s_branch K2_GEO_END_E
K2_GEO_S_E:
    ds_write_b32 v37, v35
    ds_write_b32 v37, v36 offset:256
K2_GEO_END_E:
    v_mov_b32 v5, v3
    v_mov_b32 v21, v20
    s_mov_b32 s34, s36
    s_mov_b32 s35, s37
    s_mov_b32 s36, s41
    s_cmp_lt_u32 s34, s33
    s_cbranch_scc1 K2_NODE
K2_WAVE_DONE:
    s_cmp_eq_u32 s49, 1
    s_cbranch_scc1 K2_END
    s_waitcnt vmcnt(0) lgkmcnt(0)
    s_mov_b32 s48, 0
    s_add_u32 s44, s44, s45
    s_lshl_b32 s45, s45, 1
    s_min_u32 s45, s45, 512
    s_branch K2_ROUND
K2_END:
    s_endpgm
.section .rodata,"a"
.p2align 6
.amdhsa_kernel k1_kernel
  .amdhsa_next_free_vgpr 120
  .amdhsa_next_free_sgpr 102
  .amdhsa_accum_offset 120
  .amdhsa_group_segment_fixed_size 0
  .amdhsa_kernarg_size 88
  .amdhsa_user_sgpr_count 2
  .amdhsa_user_sgpr_kernarg_segment_ptr 1
  .amdhsa_system_sgpr_workgroup_id_x 1
.end_amdhsa_kernel
.p2align 6
.amdhsa_kernel k2_kernel
  .amdhsa_next_free_vgpr 256
  .amdhsa_next_free_sgpr 102
  .amdhsa_accum_offset 256
  .amdhsa_group_segment_fixed_size 0
  .amdhsa_kernarg_size 88
  .amdhsa_user_sgpr_count 2
  .amdhsa_user_sgpr_kernarg_segment_ptr 1
  .amdhsa_system_sgpr_workgroup_id_x 1
.end_amdhsa_kernel
```
